```python
import torch

def _softmax(x, axis=-1):
    return torch.softmax(x, dim=axis)

def _gelu(x):
    return torch.nn.functional.gelu(x, approximate='tanh')

def _silu(x):
    return torch.nn.functional.silu(x)

def _sigmoid(x):
    return torch.sigmoid(x)

def _layernorm(x, axis=-1, eps=1e-05):
    m = x.mean(dim=axis, keepdim=True)
    v = x.var(dim=axis, keepdim=True, unbiased=False)
    return (x - m) / torch.sqrt(v + eps)

def _scatter_add(tgt, idx, src, axis=0):
    return tgt.clone().index_add_(axis, idx, src)

def _segment_sum(src, seg, n):
    out = torch.zeros((n,) + src.shape[1:], dtype=src.dtype)
    return out.index_add_(0, seg, src)

def _pad(x, pw):
    flat = tuple((v for pair in reversed(pw) for v in pair))
    return torch.nn.functional.pad(x, flat)
kernel_name = 'parallel_sum__memory_aug_recurrent_mem_tr__dense_activation_relu__prompt'

def setup_inputs():

    _w = lambda a: (lambda t: t.to(torch.bfloat16) if t.is_floating_point() else t)(torch.as_tensor(a))

    def _A_setup():
        B, S, Dm = (1, 2048, 448)
        H, Dh = (16, 256)
        M, seg = (8, 32)
        seg = min(seg, S)
        S = S // seg * seg
        return {'x': _w((lambda *s: torch.randn(*s, dtype=torch.bfloat16) * 0.05)(B, S, Dm)), 'mem0': _w((lambda *s: torch.randn(*s, dtype=torch.bfloat16) * 1.6)(B, M, Dm)), 'Wq': _w((lambda *s: torch.randn(*s, dtype=torch.bfloat16) * 0.8)(Dm, H, Dh) * Dm ** (-0.5)), 'Wk': _w((lambda *s: torch.randn(*s, dtype=torch.bfloat16) * 0.8)(Dm, H, Dh) * Dm ** (-0.5)), 'Wv': _w((lambda *s: torch.randn(*s, dtype=torch.bfloat16) * 1.6)(Dm, H, Dh) * Dm ** (-0.5)), 'Wo': _w((lambda *s: torch.randn(*s, dtype=torch.bfloat16) * 1.6)(H, Dh, Dm) * (H * Dh) ** (-0.5)), 'seg_len': seg}
    _A_in = _A_setup()

    def _B_setup():
        B, S, D, Dff = (1, 2048, 448, 1792)
        return {'x': _w((lambda *s: torch.randn(*s, dtype=torch.bfloat16) * 0.05)(B, S, D)), 'w1': _w((lambda *s: torch.randn(*s, dtype=torch.bfloat16) * 0.05)(D, Dff)), 'w2': _w((lambda *s: torch.randn(*s, dtype=torch.bfloat16) * 0.05)(Dff, D))}
    _B_in = _B_setup()
    return {'A_x': _A_in['x'], 'A_mem0': _A_in['mem0'], 'A_Wq': _A_in['Wq'], 'A_Wk': _A_in['Wk'], 'A_Wv': _A_in['Wv'], 'A_Wo': _A_in['Wo'], 'A_seg_len': _A_in['seg_len'], 'B_x': _B_in['x'], 'B_w1': _B_in['w1'], 'B_w2': _B_in['w2']}

def reference(A_x, A_mem0, A_Wq, A_Wk, A_Wv, A_Wo, A_seg_len, B_x, B_w1, B_w2):

    def _A_ref(x, mem0, Wq, Wk, Wv, Wo, seg_len):
        B, S, Dm = x.shape
        H, Dh = (Wq.shape[1], Wq.shape[2])
        M = mem0.shape[1]
        scale = Dh ** (-0.5)
        n_seg = S // seg_len
        L = M + seg_len
        idx = torch.arange(L)
        mask = (idx[:, None] < M) | (idx[:, None] >= idx[None, :])
        mem = mem0
        outs = []
        for s in range(n_seg):
            xs = x[:, s * seg_len:(s + 1) * seg_len, :].clone()
            h = torch.concatenate([mem, xs], axis=1)
            q = torch.einsum('btd,dhe->bhte', h, Wq)
            k = torch.einsum('btd,dhe->bhte', h, Wk)
            v = torch.einsum('btd,dhe->bhte', h, Wv)
            scores = torch.einsum('bhqe,bhke->bhqk', q, k) * scale
            scores = torch.where(mask[None, None], scores, -1000000000.0)
            p = _softmax(scores, axis=-1)
            o = torch.einsum('bhqk,bhke->bhqe', p, v)
            o = torch.einsum('bhte,hed->btd', o, Wo)
            mem = o[:, :M, :].clone()
            outs.append(o[:, M:, :])
        return torch.concatenate(outs, axis=1)

    def _B_ref(x, w1, w2):
        h = torch.einsum('bsd,df->bsf', x, w1)
        zero = torch.zeros_like(h)
        h = torch.maximum(h, zero)
        return torch.einsum('bsf,fd->bsd', h, w2)
    x = A_x
    xn = _layernorm(x, axis=-1)
    return x + _A_ref(xn, A_mem0, A_Wq, A_Wk, A_Wv, A_Wo, A_seg_len) + _B_ref(xn, B_w1, B_w2)
```

```asm
; @launch kernel=main_kernel grid=(256,1,1) block=(256,1,1) lds=163840
.amdgcn_target "amdgcn-amd-amdhsa--gfx950"
.text
.globl main_kernel
.p2align 8
.type main_kernel,@function
main_kernel:
  s_cmp_ge_u32 s2, 256
  s_cbranch_scc1 W_quit
  s_load_dwordx2 s[8:9], s[0:1], 96
  s_mov_b32 s10, 0x10000000
  s_mov_b32 s11, 0x20000
  s_load_dwordx2 s[4:5], s[0:1], 88
  s_mov_b32 s6, 0x100
  s_mov_b32 s7, 0x20000
  s_load_dwordx2 s[60:61], s[0:1], 0
  s_mov_b32 s62, 0x1c0000
  s_mov_b32 s63, 0x20000
  s_load_dwordx2 s[64:65], s[0:1], 8
  s_mov_b32 s66, 0x1c00
  s_mov_b32 s67, 0x20000
  s_and_b32 s42, s2, 7
  s_lshr_b32 s16, s2, 3
  s_lshr_b32 s27, s42, 2
  s_and_b32 s26, s42, 3
  s_xor_b32 s27, s27, 1
  s_cbranch_scc1 Z_srdB
  s_load_dwordx2 s[52:53], s[0:1], 16
  s_mov_b32 s54, 0x380000
  s_mov_b32 s55, 0x20000
  s_load_dwordx2 s[56:57], s[0:1], 24
  s_mov_b32 s58, 0x380000
  s_mov_b32 s59, 0x20000
  s_branch Z_srd
Z_srdB:
  s_load_dwordx2 s[52:53], s[0:1], 32
  s_mov_b32 s54, 0x380000
  s_mov_b32 s55, 0x20000
  s_load_dwordx2 s[56:57], s[0:1], 40
  s_mov_b32 s58, 0x380000
  s_mov_b32 s59, 0x20000
Z_srd:
  v_and_b32 v1, 63, v0
  v_lshrrev_b32 v2, 6, v0
  s_nop 0
  v_readfirstlane_b32 s13, v2
  v_lshlrev_b32 v2, 4, v1
  v_mov_b32 v3, 0
  v_mov_b32 v5, 1
  v_mov_b32 v4, 0x7f000000
  v_cmp_eq_u32 vcc, 0, v0
  s_nop 1
  v_cndmask_b32 v4, v4, v3, vcc
  s_mov_b32 s25, 65536
  s_lshl_b32 s26, s26, 2
  s_lshr_b32 s17, s16, 3
  s_add_u32 s26, s26, s17
  s_and_b32 s37, s16, 1
  s_bfe_u32 s38, s16, 0x20001
  s_lshl_b32 s36, s2, 2
  s_add_u32 s36, s36, s13
  v_and_b32 v8, 31, v1
  v_lshrrev_b32 v9, 5, v1
  v_mul_u32_u24 v10, 896, v9
  v_lshl_add_u32 v10, v8, 4, v10
  v_mov_b32 v13, 0x7f000000
  v_cmp_gt_u32 s[44:45], 28, v8
  s_nop 1
  v_cndmask_b32 v10, v13, v10, s[44:45]
  s_mul_i32 s17, s36, 1792
  v_bfe_u32 v11, v1, 2, 3
  v_mul_u32_u24 v11, 896, v11
  v_and_b32 v12, 3, v1
  v_lshl_add_u32 v11, v12, 3, v11
  v_lshl_add_u32 v11, v9, 2, v11
  s_lshl_b32 s18, s36, 5
  s_cmp_lt_u32 s36, 28
  s_cselect_b32 s18, s18, 0x7f000000
  s_waitcnt lgkmcnt(0)
  s_cmp_lg_u32 s36, 135
  s_cselect_b32 s40, 0x7f000000, 0
  s_cbranch_scc1 Z_nz
  v_mov_b32 v216, 0
  v_mov_b32 v217, 0
  v_mov_b32 v218, 0
  v_mov_b32 v219, 0
  v_lshrrev_b32 v12, 3, v1
  v_mul_u32_u24 v12, 4352, v12
  v_and_b32 v14, 7, v1
  v_lshl_add_u32 v12, v14, 4, v12
  s_mov_b32 s19, 1638400
  buffer_store_dwordx4 v[216:219], v12, s[8:11], s19 offen sc1
  s_add_u32 s19, s19, 34816
  buffer_store_dwordx4 v[216:219], v12, s[8:11], s19 offen sc1
  s_add_u32 s19, s19, 34816
  buffer_store_dwordx4 v[216:219], v12, s[8:11], s19 offen sc1
  s_add_u32 s19, s19, 34816
  buffer_store_dwordx4 v[216:219], v12, s[8:11], s19 offen sc1
  s_add_u32 s19, s19, 34816
  buffer_store_dwordx4 v[216:219], v12, s[8:11], s19 offen sc1
  s_add_u32 s19, s19, 34816
  buffer_store_dwordx4 v[216:219], v12, s[8:11], s19 offen sc1
  s_add_u32 s19, s19, 34816
  buffer_store_dwordx4 v[216:219], v12, s[8:11], s19 offen sc1
  s_add_u32 s19, s19, 34816
Z_nz:
  buffer_load_dwordx4 v[40:43], v10, s[60:63], s17 offen
  buffer_load_dwordx4 v[44:47], v10, s[60:63], s17 offen offset:448
  buffer_load_dword v35, v11, s[64:67], s18 offen
  s_lshl_b32 s17, s16, 2
  s_add_u32 s17, s17, s13
  s_mul_i32 s17, s17, 56
  v_min_u32 v12, 55, v1
  v_add_u32 v12, s17, v12
  v_lshrrev_b32 v14, 4, v12
  v_and_b32 v15, 15, v12
  v_lshlrev_b32 v15, 7, v15
  v_lshl_add_u32 v14, v14, 13, v15
  v_lshlrev_b32 v12, 7, v12
  s_and_b32 s17, s26, 12
  s_mul_i32 s18, s17, 229376
  s_lshl_b32 s17, s17, 9
  s_cmp_eq_u32 s27, 0
  s_cselect_b64 vcc, -1, 0
  s_cselect_b32 s18, s17, s18
  v_cndmask_b32 v12, v12, v14, vcc
  buffer_load_dword v15, v12, s[56:59], s18 offen
  buffer_load_dword v15, v14, s[52:55], s17 offen
  s_lshl_b32 s33, s38, 2
  s_cmp_eq_u32 s38, 3
  s_cselect_b32 s33, 11, s33
  s_add_u32 s33, s33, s13
  s_lshr_b32 s17, s38, 1
  s_add_u32 s17, s17, s13
  s_cmp_eq_u32 s17, 4
  s_cselect_b32 s39, 0x7f000000, 0
  s_lshl_b32 s17, s27, 4
  s_add_u32 s17, s17, s26
  s_mul_i32 s17, s17, 14
  s_add_u32 s17, s17, s33
  s_mul_i32 s29, s17, 28672
  s_lshl_b32 s17, s37, 11
  s_add_u32 s29, s29, s17
  s_add_u32 s29, s29, 3719168
  s_add_u32 s29, s29, s39
  s_lshl_b32 s17, s26, 1
  s_add_u32 s17, s17, s27
  s_mul_i32 s32, s17, 4352
  s_lshl_b32 s17, s33, 1
  s_add_u32 s17, s17, s37
  s_lshl_b32 s17, s17, 2
  s_add_u32 s32, s32, s17
  s_add_u32 s32, s32, 1638400
  s_add_u32 s32, s32, s39
  s_lshr_b32 s17, s36, 4
  s_mul_i32 s17, s17, 28672
  s_and_b32 s18, s36, 15
  s_lshl_b32 s18, s18, 5
  s_add_u32 s17, s17, s18
  s_add_u32 s41, s17, 1884160
  s_waitcnt vmcnt(2)
  v_mov_b32 v12, 32
  buffer_store_dword v12, v3, s[4:7], s40 offen offset:160 sc1
  v_lshlrev_b32 v200, 16, v40
  v_and_b32 v201, 0xffff0000, v40
  v_lshlrev_b32 v202, 16, v41
  v_and_b32 v203, 0xffff0000, v41
  v_lshlrev_b32 v204, 16, v42
  v_and_b32 v205, 0xffff0000, v42
  v_lshlrev_b32 v206, 16, v43
  v_and_b32 v207, 0xffff0000, v43
  v_lshlrev_b32 v208, 16, v44
  v_and_b32 v209, 0xffff0000, v44
  v_lshlrev_b32 v210, 16, v45
  v_and_b32 v211, 0xffff0000, v45
  v_lshlrev_b32 v212, 16, v46
  v_and_b32 v213, 0xffff0000, v46
  v_lshlrev_b32 v214, 16, v47
  v_and_b32 v215, 0xffff0000, v47
  v_pk_add_f32 v[216:217], v[200:201], v[202:203]
  v_pk_add_f32 v[218:219], v[204:205], v[206:207]
  v_pk_add_f32 v[220:221], v[208:209], v[210:211]
  v_pk_add_f32 v[222:223], v[212:213], v[214:215]
  v_pk_add_f32 v[216:217], v[216:217], v[218:219]
  v_pk_add_f32 v[220:221], v[220:221], v[222:223]
  v_pk_add_f32 v[216:217], v[216:217], v[220:221]
  v_add_f32 v216, v216, v217
  s_nop 1
  v_add_f32_dpp v216, v216, v216 quad_perm:[1,0,3,2] row_mask:0xf bank_mask:0xf
  s_nop 1
  v_add_f32_dpp v216, v216, v216 quad_perm:[2,3,0,1] row_mask:0xf bank_mask:0xf
  s_nop 1
  v_add_f32_dpp v216, v216, v216 row_half_mirror row_mask:0xf bank_mask:0xf
  s_nop 1
  v_add_f32_dpp v216, v216, v216 row_mirror row_mask:0xf bank_mask:0xf
  v_mov_b32 v217, v216
  s_nop 1
  v_permlane16_swap_b32 v216, v217
  v_add_f32 v216, v216, v217
  v_mul_f32 v216, 0x3b124925, v216
  v_mov_b32 v218, 0
  v_mov_b32 v219, 0
  v_pk_add_f32 v[220:221], v[200:201], v[216:217] op_sel_hi:[1,0] neg_lo:[0,1] neg_hi:[0,1]
  v_pk_fma_f32 v[218:219], v[220:221], v[220:221], v[218:219]
  v_pk_add_f32 v[222:223], v[202:203], v[216:217] op_sel_hi:[1,0] neg_lo:[0,1] neg_hi:[0,1]
  v_pk_fma_f32 v[218:219], v[222:223], v[222:223], v[218:219]
  v_pk_add_f32 v[220:221], v[204:205], v[216:217] op_sel_hi:[1,0] neg_lo:[0,1] neg_hi:[0,1]
  v_pk_fma_f32 v[218:219], v[220:221], v[220:221], v[218:219]
  v_pk_add_f32 v[222:223], v[206:207], v[216:217] op_sel_hi:[1,0] neg_lo:[0,1] neg_hi:[0,1]
  v_pk_fma_f32 v[218:219], v[222:223], v[222:223], v[218:219]
  v_pk_add_f32 v[220:221], v[208:209], v[216:217] op_sel_hi:[1,0] neg_lo:[0,1] neg_hi:[0,1]
  v_pk_fma_f32 v[218:219], v[220:221], v[220:221], v[218:219]
  v_pk_add_f32 v[222:223], v[210:211], v[216:217] op_sel_hi:[1,0] neg_lo:[0,1] neg_hi:[0,1]
  v_pk_fma_f32 v[218:219], v[222:223], v[222:223], v[218:219]
  v_pk_add_f32 v[220:221], v[212:213], v[216:217] op_sel_hi:[1,0] neg_lo:[0,1] neg_hi:[0,1]
  v_pk_fma_f32 v[218:219], v[220:221], v[220:221], v[218:219]
  v_pk_add_f32 v[222:223], v[214:215], v[216:217] op_sel_hi:[1,0] neg_lo:[0,1] neg_hi:[0,1]
  v_pk_fma_f32 v[218:219], v[222:223], v[222:223], v[218:219]
  v_add_f32 v218, v218, v219
  v_cndmask_b32 v218, 0, v218, s[44:45]
  s_nop 1
  v_add_f32_dpp v218, v218, v218 quad_perm:[1,0,3,2] row_mask:0xf bank_mask:0xf
  s_nop 1
  v_add_f32_dpp v218, v218, v218 quad_perm:[2,3,0,1] row_mask:0xf bank_mask:0xf
  s_nop 1
  v_add_f32_dpp v218, v218, v218 row_half_mirror row_mask:0xf bank_mask:0xf
  s_nop 1
  v_add_f32_dpp v218, v218, v218 row_mirror row_mask:0xf bank_mask:0xf
  v_mov_b32 v219, v218
  s_nop 1
  v_permlane16_swap_b32 v218, v219
  v_add_f32 v218, v218, v219
  v_mul_f32 v218, 0x3b124925, v218
  v_cvt_pk_bf16_f32 v219, v216, v218
  v_lshlrev_b32 v216, 16, v219
  v_and_b32 v218, 0xffff0000, v219
  v_add_f32 v218, 0x3727c5ac, v218
  v_cvt_pk_bf16_f32 v218, v218, v218
  v_lshlrev_b32 v218, 16, v218
  v_sqrt_f32 v218, v218
  s_nop 0
  v_cvt_pk_bf16_f32 v218, v218, v218
  v_lshlrev_b32 v218, 16, v218
  v_rcp_f32 v220, v218
  v_pk_add_f32 v[200:201], v[200:201], v[216:217] op_sel_hi:[1,0] neg_lo:[0,1] neg_hi:[0,1]
  v_cvt_pk_bf16_f32 v222, v200, v201
  v_lshlrev_b32 v200, 16, v222
  v_and_b32 v201, 0xffff0000, v222
  v_pk_mul_f32 v[222:223], v[200:201], v[220:221] op_sel_hi:[1,0]
  v_pk_fma_f32 v[224:225], v[222:223], v[218:219], v[200:201] op_sel_hi:[1,0,1] neg_lo:[1,0,0] neg_hi:[1,0,0]
  v_pk_fma_f32 v[222:223], v[224:225], v[220:221], v[222:223] op_sel_hi:[1,0,1]
  v_cvt_pk_bf16_f32 v40, v222, v223
  v_pk_add_f32 v[202:203], v[202:203], v[216:217] op_sel_hi:[1,0] neg_lo:[0,1] neg_hi:[0,1]
  v_cvt_pk_bf16_f32 v226, v202, v203
  v_lshlrev_b32 v202, 16, v226
  v_and_b32 v203, 0xffff0000, v226
  v_pk_mul_f32 v[226:227], v[202:203], v[220:221] op_sel_hi:[1,0]
  v_pk_fma_f32 v[228:229], v[226:227], v[218:219], v[202:203] op_sel_hi:[1,0,1] neg_lo:[1,0,0] neg_hi:[1,0,0]
  v_pk_fma_f32 v[226:227], v[228:229], v[220:221], v[226:227] op_sel_hi:[1,0,1]
  v_cvt_pk_bf16_f32 v41, v226, v227
  v_pk_add_f32 v[204:205], v[204:205], v[216:217] op_sel_hi:[1,0] neg_lo:[0,1] neg_hi:[0,1]
  v_cvt_pk_bf16_f32 v222, v204, v205
  v_lshlrev_b32 v204, 16, v222
  v_and_b32 v205, 0xffff0000, v222
  v_pk_mul_f32 v[222:223], v[204:205], v[220:221] op_sel_hi:[1,0]
  v_pk_fma_f32 v[224:225], v[222:223], v[218:219], v[204:205] op_sel_hi:[1,0,1] neg_lo:[1,0,0] neg_hi:[1,0,0]
  v_pk_fma_f32 v[222:223], v[224:225], v[220:221], v[222:223] op_sel_hi:[1,0,1]
  v_cvt_pk_bf16_f32 v42, v222, v223
  v_pk_add_f32 v[206:207], v[206:207], v[216:217] op_sel_hi:[1,0] neg_lo:[0,1] neg_hi:[0,1]
  v_cvt_pk_bf16_f32 v226, v206, v207
  v_lshlrev_b32 v206, 16, v226
  v_and_b32 v207, 0xffff0000, v226
  v_pk_mul_f32 v[226:227], v[206:207], v[220:221] op_sel_hi:[1,0]
  v_pk_fma_f32 v[228:229], v[226:227], v[218:219], v[206:207] op_sel_hi:[1,0,1] neg_lo:[1,0,0] neg_hi:[1,0,0]
  v_pk_fma_f32 v[226:227], v[228:229], v[220:221], v[226:227] op_sel_hi:[1,0,1]
  v_cvt_pk_bf16_f32 v43, v226, v227
  v_pk_add_f32 v[208:209], v[208:209], v[216:217] op_sel_hi:[1,0] neg_lo:[0,1] neg_hi:[0,1]
  v_cvt_pk_bf16_f32 v222, v208, v209
  v_lshlrev_b32 v208, 16, v222
  v_and_b32 v209, 0xffff0000, v222
  v_pk_mul_f32 v[222:223], v[208:209], v[220:221] op_sel_hi:[1,0]
  v_pk_fma_f32 v[224:225], v[222:223], v[218:219], v[208:209] op_sel_hi:[1,0,1] neg_lo:[1,0,0] neg_hi:[1,0,0]
  v_pk_fma_f32 v[222:223], v[224:225], v[220:221], v[222:223] op_sel_hi:[1,0,1]
  v_cvt_pk_bf16_f32 v44, v222, v223
  v_pk_add_f32 v[210:211], v[210:211], v[216:217] op_sel_hi:[1,0] neg_lo:[0,1] neg_hi:[0,1]
  v_cvt_pk_bf16_f32 v226, v210, v211
  v_lshlrev_b32 v210, 16, v226
  v_and_b32 v211, 0xffff0000, v226
  v_pk_mul_f32 v[226:227], v[210:211], v[220:221] op_sel_hi:[1,0]
  v_pk_fma_f32 v[228:229], v[226:227], v[218:219], v[210:211] op_sel_hi:[1,0,1] neg_lo:[1,0,0] neg_hi:[1,0,0]
  v_pk_fma_f32 v[226:227], v[228:229], v[220:221], v[226:227] op_sel_hi:[1,0,1]
  v_cvt_pk_bf16_f32 v45, v226, v227
  v_pk_add_f32 v[212:213], v[212:213], v[216:217] op_sel_hi:[1,0] neg_lo:[0,1] neg_hi:[0,1]
  v_cvt_pk_bf16_f32 v222, v212, v213
  v_lshlrev_b32 v212, 16, v222
  v_and_b32 v213, 0xffff0000, v222
  v_pk_mul_f32 v[222:223], v[212:213], v[220:221] op_sel_hi:[1,0]
  v_pk_fma_f32 v[224:225], v[222:223], v[218:219], v[212:213] op_sel_hi:[1,0,1] neg_lo:[1,0,0] neg_hi:[1,0,0]
  v_pk_fma_f32 v[222:223], v[224:225], v[220:221], v[222:223] op_sel_hi:[1,0,1]
  v_cvt_pk_bf16_f32 v46, v222, v223
  v_pk_add_f32 v[214:215], v[214:215], v[216:217] op_sel_hi:[1,0] neg_lo:[0,1] neg_hi:[0,1]
  v_cvt_pk_bf16_f32 v226, v214, v215
  v_lshlrev_b32 v214, 16, v226
  v_and_b32 v215, 0xffff0000, v226
  v_pk_mul_f32 v[226:227], v[214:215], v[220:221] op_sel_hi:[1,0]
  v_pk_fma_f32 v[228:229], v[226:227], v[218:219], v[214:215] op_sel_hi:[1,0,1] neg_lo:[1,0,0] neg_hi:[1,0,0]
  v_pk_fma_f32 v[226:227], v[228:229], v[220:221], v[226:227] op_sel_hi:[1,0,1]
  v_cvt_pk_bf16_f32 v47, v226, v227
  s_sub_u32 s20, 9, s13
  s_lshl_b32 s20, s20, 14
  s_mov_b32 m0, s20
  s_mov_b32 s30, 0
  v_xor_b32 v10, v9, v8
  s_cmp_eq_u32 s27, 0
  s_cbranch_scc0 Z_cB
  v_lshlrev_b32 v11, 13, v9
  s_lshl_b32 s17, s33, 18
  s_lshl_b32 s18, s26, 9
  s_add_u32 s19, s17, s18
  s_add_u32 s19, s19, s39
  s_mov_b32 s34, 0x3db8aa3b
Z_cA1:
  v_xor_b32 v12, s30, v10
  v_lshl_add_u32 v12, v12, 4, v11
  s_add_u32 s17, s19, 131072
  buffer_load_dwordx4 v12, s[56:59], s19 offen lds
  s_add_u32 m0, m0, 8192
  s_add_u32 s19, s19, 16384
  buffer_load_dwordx4 v12, s[56:59], s17 offen lds
  s_sub_u32 m0, m0, 7168
  s_add_u32 s30, s30, 2
  s_cmp_lt_u32 s30, 16
  s_cbranch_scc1 Z_cA1
  s_branch Z_c
Z_cB:
  v_lshrrev_b32 v12, 2, v1
  v_mul_u32_u24 v12, 896, v12
  v_and_b32 v11, 3, v1
  v_lshl_add_u32 v12, v11, 4, v12
  s_mul_i32 s19, s26, 229376
  s_lshl_b32 s17, s33, 6
  s_add_u32 s19, s19, s17
  s_add_u32 s19, s19, s39
  s_mov_b32 s34, 1.0
Z_cB1:
  buffer_load_dwordx4 v12, s[56:59], s19 offen lds
  s_add_u32 s19, s19, 14336
  s_add_u32 m0, m0, 1024
  s_add_u32 s30, s30, 1
  s_cmp_lt_u32 s30, 16
  s_cbranch_scc1 Z_cB1
Z_c:
  s_and_b32 s17, s13, 1
  s_lshl_b32 s17, s17, 3
  v_xor_b32 v10, s17, v10
  v_xor_b32 v11, 0, v10
  v_lshlrev_b32 v11, 4, v11
  v_lshl_add_u32 v11, v9, 13, v11
  v_add_u32 v16, 0, v11
  v_xor_b32 v11, 2, v10
  v_lshlrev_b32 v11, 4, v11
  v_lshl_add_u32 v11, v9, 13, v11
  v_add_u32 v17, 15360, v11
  v_xor_b32 v11, 4, v10
  v_lshlrev_b32 v11, 4, v11
  v_lshl_add_u32 v11, v9, 13, v11
  v_add_u32 v18, 30720, v11
  v_xor_b32 v11, 6, v10
  v_lshlrev_b32 v11, 4, v11
  v_lshl_add_u32 v11, v9, 13, v11
  v_add_u32 v19, 46080, v11
  s_lshl_b32 s28, s26, 9
  s_lshl_b32 s17, s13, 16
  s_add_u32 s28, s28, s17
  s_lshl_b32 s17, s37, 18
  s_add_u32 s28, s28, s17
  s_lshl_b32 s31, s13, 12
  v_lshlrev_b32 v32, 2, v0
  s_cmp_eq_u32 s42, 0
  s_cselect_b32 s17, 0, 0x3f800000
  v_add_u32 v36, s17, v2
  s_mov_b32 m0, s31
  s_nop 0
  buffer_load_dwordx4 v16, s[52:55], s28 offen offset:0 lds
  buffer_load_dwordx4 v17, s[52:55], s28 offen offset:1024 lds
  buffer_load_dwordx4 v18, s[52:55], s28 offen offset:2048 lds
  buffer_load_dwordx4 v19, s[52:55], s28 offen offset:3072 lds
  s_add_u32 s28, s28, 524288
  s_add_u32 s31, s31, 0x4000
  s_mov_b32 m0, s31
  s_nop 0
  buffer_load_dwordx4 v16, s[52:55], s28 offen offset:0 lds
  buffer_load_dwordx4 v17, s[52:55], s28 offen offset:1024 lds
  buffer_load_dwordx4 v18, s[52:55], s28 offen offset:2048 lds
  buffer_load_dwordx4 v19, s[52:55], s28 offen offset:3072 lds
  s_add_u32 s28, s28, 524288
  s_add_u32 s31, s31, 0x4000
  s_mov_b32 m0, s31
  s_nop 0
  buffer_load_dwordx4 v16, s[52:55], s28 offen offset:0 lds
  buffer_load_dwordx4 v17, s[52:55], s28 offen offset:1024 lds
  buffer_load_dwordx4 v18, s[52:55], s28 offen offset:2048 lds
  buffer_load_dwordx4 v19, s[52:55], s28 offen offset:3072 lds
  s_add_u32 s28, s28, 524288
  s_add_u32 s31, s31, 0x4000
  s_mov_b32 m0, s31
  s_nop 0
  buffer_load_dwordx4 v16, s[52:55], s28 offen offset:0 lds
  buffer_load_dwordx4 v17, s[52:55], s28 offen offset:1024 lds
  buffer_load_dwordx4 v18, s[52:55], s28 offen offset:2048 lds
  buffer_load_dwordx4 v19, s[52:55], s28 offen offset:3072 lds
  s_add_u32 s28, s28, 524288
  s_add_u32 s31, s31, 0x4000
  v_lshlrev_b32 v10, 9, v8
  v_lshl_add_u32 v10, v9, 4, v10
  v_cndmask_b32 v10, v13, v10, s[44:45]
  s_add_u32 s18, s41, 14336
  buffer_store_dwordx4 v[40:43], v10, s[8:11], s41 offen sc1
  buffer_store_dwordx4 v[44:47], v10, s[8:11], s18 offen sc1
  s_cmp_lt_u32 s36, 64
  s_cselect_b32 s17, 0, -1
  v_mov_b32 v200, s17
  v_mov_b32 v204, -1
  v_mov_b32 v201, s17
  v_mov_b32 v205, -1
  v_mov_b32 v202, s17
  v_mov_b32 v206, -1
  v_mov_b32 v203, s17
  v_mov_b32 v207, -1
  s_lshl_b32 s17, s36, 10
  s_add_u32 s18, s17, 0x100000
  s_sub_u32 s19, s36, 64
  s_cmp_lt_u32 s19, 7
  s_cselect_b32 s17, 0x7f000000, s17
  s_cmp_ge_u32 s18, 0x190000
  s_cselect_b32 s18, 0x7f000000, s18
  buffer_store_dwordx4 v[200:203], v2, s[8:11], s17 offen sc1
  buffer_store_dwordx4 v[204:207], v2, s[8:11], s18 offen sc1
  v_min_u32 v35, -2, v35
  v_lshlrev_b32 v11, 2, v1
  s_lshl_b32 s17, s36, 8
  s_add_u32 s17, s17, 65536
  s_cmp_lt_u32 s36, 28
  s_cselect_b32 s17, s17, 0x7f000000
  buffer_store_dword v35, v11, s[8:11], s17 offen sc1
  s_mov_b32 s35, s34
  v_and_b32 v10, 0x33, v8
  v_bfe_u32 v11, v8, 2, 1
  v_lshl_or_b32 v10, v11, 3, v10
  v_bfe_u32 v11, v8, 3, 1
  v_lshl_or_b32 v10, v11, 2, v10
  v_and_b32 v11, 15, v10
  v_xor_b32 v11, v11, v9
  v_xor_b32 v12, 0, v11
  v_lshlrev_b32 v12, 4, v12
  v_lshl_add_u32 v24, v10, 9, v12
  v_add_u32 v160, s20, v24
  v_xor_b32 v12, 2, v11
  v_lshlrev_b32 v12, 4, v12
  v_lshl_add_u32 v25, v10, 9, v12
  v_add_u32 v161, s20, v25
  v_xor_b32 v12, 4, v11
  v_lshlrev_b32 v12, 4, v12
  v_lshl_add_u32 v26, v10, 9, v12
  v_add_u32 v162, s20, v26
  v_xor_b32 v12, 6, v11
  v_lshlrev_b32 v12, 4, v12
  v_lshl_add_u32 v27, v10, 9, v12
  v_add_u32 v163, s20, v27
  v_xor_b32 v12, 8, v11
  v_lshlrev_b32 v12, 4, v12
  v_lshl_add_u32 v28, v10, 9, v12
  v_add_u32 v164, s20, v28
  v_xor_b32 v12, 10, v11
  v_lshlrev_b32 v12, 4, v12
  v_lshl_add_u32 v29, v10, 9, v12
  v_add_u32 v165, s20, v29
  v_xor_b32 v12, 12, v11
  v_lshlrev_b32 v12, 4, v12
  v_lshl_add_u32 v30, v10, 9, v12
  v_add_u32 v166, s20, v30
  v_xor_b32 v12, 14, v11
  v_lshlrev_b32 v12, 4, v12
  v_lshl_add_u32 v31, v10, 9, v12
  v_add_u32 v167, s20, v31
  v_bfe_u32 v14, v1, 5, 1
  v_lshlrev_b32 v12, 9, v14
  v_bfe_u32 v14, v1, 2, 2
  v_lshl_or_b32 v12, v14, 6, v12
  v_bfe_u32 v14, v1, 4, 1
  v_lshl_or_b32 v12, v14, 5, v12
  v_and_b32 v14, 1, v1
  v_lshl_or_b32 v12, v14, 4, v12
  v_bfe_u32 v14, v1, 1, 1
  v_lshl_or_b32 v12, v14, 3, v12
  v_add_u32 v12, s20, v12
  v_cmp_eq_u32 vcc, 0, v1
  s_nop 1
  v_cndmask_b32 v13, v13, v3, vcc
  s_mov_b32 s30, 0
  s_waitcnt vmcnt(21)
  s_cmp_eq_u32 s27, 0
  s_cbranch_scc0 Z_rB
  ds_read_b128 v[64:67], v160 offset:0
  ds_read_b128 v[68:71], v161 offset:0
  ds_read_b128 v[72:75], v162 offset:0
  ds_read_b128 v[76:79], v163 offset:0
  ds_read_b128 v[80:83], v164 offset:0
  ds_read_b128 v[84:87], v165 offset:0
  ds_read_b128 v[88:91], v166 offset:0
  ds_read_b128 v[92:95], v167 offset:0
  ds_read_b128 v[96:99], v160 offset:256
  ds_read_b128 v[100:103], v161 offset:256
  ds_read_b128 v[104:107], v162 offset:256
  ds_read_b128 v[108:111], v163 offset:256
  ds_read_b128 v[112:115], v164 offset:256
  ds_read_b128 v[116:119], v165 offset:256
  ds_read_b128 v[120:123], v166 offset:256
  ds_read_b128 v[124:127], v167 offset:256
  s_branch Z_go
Z_rB:
  ds_read_b64_tr_b16 v[64:65], v12 offset:0
  ds_read_b64_tr_b16 v[66:67], v12 offset:256
  ds_read_b64_tr_b16 v[68:69], v12 offset:1024
  ds_read_b64_tr_b16 v[70:71], v12 offset:1280
  ds_read_b64_tr_b16 v[72:73], v12 offset:2048
  ds_read_b64_tr_b16 v[74:75], v12 offset:2304
  ds_read_b64_tr_b16 v[76:77], v12 offset:3072
  ds_read_b64_tr_b16 v[78:79], v12 offset:3328
  ds_read_b64_tr_b16 v[80:81], v12 offset:4096
  ds_read_b64_tr_b16 v[82:83], v12 offset:4352
  ds_read_b64_tr_b16 v[84:85], v12 offset:5120
  ds_read_b64_tr_b16 v[86:87], v12 offset:5376
  ds_read_b64_tr_b16 v[88:89], v12 offset:6144
  ds_read_b64_tr_b16 v[90:91], v12 offset:6400
  ds_read_b64_tr_b16 v[92:93], v12 offset:7168
  ds_read_b64_tr_b16 v[94:95], v12 offset:7424
  ds_read_b64_tr_b16 v[96:97], v12 offset:8192
  ds_read_b64_tr_b16 v[98:99], v12 offset:8448
  ds_read_b64_tr_b16 v[100:101], v12 offset:9216
  ds_read_b64_tr_b16 v[102:103], v12 offset:9472
  ds_read_b64_tr_b16 v[104:105], v12 offset:10240
  ds_read_b64_tr_b16 v[106:107], v12 offset:10496
  ds_read_b64_tr_b16 v[108:109], v12 offset:11264
  ds_read_b64_tr_b16 v[110:111], v12 offset:11520
  ds_read_b64_tr_b16 v[112:113], v12 offset:12288
  ds_read_b64_tr_b16 v[114:115], v12 offset:12544
  ds_read_b64_tr_b16 v[116:117], v12 offset:13312
  ds_read_b64_tr_b16 v[118:119], v12 offset:13568
  ds_read_b64_tr_b16 v[120:121], v12 offset:14336
  ds_read_b64_tr_b16 v[122:123], v12 offset:14592
  ds_read_b64_tr_b16 v[124:125], v12 offset:15360
  ds_read_b64_tr_b16 v[126:127], v12 offset:15616
Z_go:
  s_waitcnt vmcnt(17)
  s_waitcnt lgkmcnt(0)
  s_barrier
  ds_read_b128 v[160:163], v24 offset:0
  ds_read_b128 v[164:167], v25 offset:0
  ds_read_b128 v[168:171], v26 offset:0
  ds_read_b128 v[172:175], v27 offset:0
  ds_read_b128 v[176:179], v28 offset:0
  ds_read_b128 v[180:183], v29 offset:0
  s_waitcnt lgkmcnt(5)
  v_mfma_f32_32x32x16_bf16 v[128:143], v[160:163], v[64:67], 0
  ds_read_b128 v[184:187], v30 offset:0
  s_mov_b32 m0, s31
  s_nop 0
  buffer_load_dwordx4 v16, s[52:55], s28 offen offset:0 lds
  s_waitcnt lgkmcnt(5)
  v_mfma_f32_32x32x16_bf16 v[128:143], v[164:167], v[68:71], v[128:143]
  ds_read_b128 v[188:191], v31 offset:0
  buffer_load_dwordx4 v17, s[52:55], s28 offen offset:1024 lds
  buffer_load_dwordx4 v18, s[52:55], s28 offen offset:2048 lds
  s_waitcnt lgkmcnt(5)
  v_mfma_f32_32x32x16_bf16 v[128:143], v[168:171], v[72:75], v[128:143]
  ds_read_b128 v[160:163], v24 offset:256
  buffer_load_dwordx4 v19, s[52:55], s28 offen offset:3072 lds
  s_add_u32 s28, s28, 524288
  s_waitcnt lgkmcnt(5)
  v_mfma_f32_32x32x16_bf16 v[128:143], v[172:175], v[76:79], v[128:143]
  ds_read_b128 v[164:167], v25 offset:256
  s_add_u32 s31, s31, 0x4000
  s_mov_b32 m0, s31
  s_waitcnt lgkmcnt(5)
  v_mfma_f32_32x32x16_bf16 v[128:143], v[176:179], v[80:83], v[128:143]
  ds_read_b128 v[168:171], v26 offset:256
  buffer_load_dwordx4 v16, s[52:55], s28 offen offset:0 lds
  buffer_load_dwordx4 v17, s[52:55], s28 offen offset:1024 lds
  s_waitcnt lgkmcnt(5)
  v_mfma_f32_32x32x16_bf16 v[128:143], v[180:183], v[84:87], v[128:143]
  ds_read_b128 v[172:175], v27 offset:256
  buffer_load_dwordx4 v18, s[52:55], s28 offen offset:2048 lds
  buffer_load_dwordx4 v19, s[52:55], s28 offen offset:3072 lds
  s_waitcnt lgkmcnt(5)
  v_mfma_f32_32x32x16_bf16 v[128:143], v[184:187], v[88:91], v[128:143]
  ds_read_b128 v[176:179], v28 offset:256
  s_add_u32 s28, s28, 524288
  s_add_u32 s31, s31, 0x4000
  s_waitcnt lgkmcnt(5)
  v_mfma_f32_32x32x16_bf16 v[128:143], v[188:191], v[92:95], v[128:143]
  ds_read_b128 v[180:183], v29 offset:256
  s_mov_b32 m0, s31
  s_nop 0
  buffer_load_dwordx4 v16, s[52:55], s28 offen offset:0 lds
  s_waitcnt lgkmcnt(5)
  v_mfma_f32_32x32x16_bf16 v[128:143], v[160:163], v[96:99], v[128:143]
  ds_read_b128 v[184:187], v30 offset:256
  buffer_load_dwordx4 v17, s[52:55], s28 offen offset:1024 lds
  buffer_load_dwordx4 v18, s[52:55], s28 offen offset:2048 lds
  s_waitcnt lgkmcnt(5)
  v_mfma_f32_32x32x16_bf16 v[128:143], v[164:167], v[100:103], v[128:143]
  ds_read_b128 v[188:191], v31 offset:256
  buffer_load_dwordx4 v19, s[52:55], s28 offen offset:3072 lds
  s_add_u32 s28, s28, 524288
  s_waitcnt lgkmcnt(5)
  v_mfma_f32_32x32x16_bf16 v[128:143], v[168:171], v[104:107], v[128:143]
  s_waitcnt vmcnt(25)
  s_barrier
  ds_read_b128 v[160:163], v24 offset:16384
  s_add_u32 s31, s31, 0x4000
  buffer_load_dword v33, v32, s[4:7], 0 offen sc1
  s_waitcnt lgkmcnt(5)
  v_mfma_f32_32x32x16_bf16 v[128:143], v[172:175], v[108:111], v[128:143]
  ds_read_b128 v[164:167], v25 offset:16384
  s_waitcnt lgkmcnt(5)
  v_mfma_f32_32x32x16_bf16 v[128:143], v[176:179], v[112:115], v[128:143]
  ds_read_b128 v[168:171], v26 offset:16384
  s_waitcnt lgkmcnt(5)
  v_mfma_f32_32x32x16_bf16 v[128:143], v[180:183], v[116:119], v[128:143]
  ds_read_b128 v[172:175], v27 offset:16384
  s_waitcnt lgkmcnt(5)
  v_mfma_f32_32x32x16_bf16 v[128:143], v[184:187], v[120:123], v[128:143]
  ds_read_b128 v[176:179], v28 offset:16384
  s_waitcnt lgkmcnt(5)
  v_mfma_f32_32x32x16_bf16 v[128:143], v[188:191], v[124:127], v[128:143]
  ds_read_b128 v[180:183], v29 offset:16384
  s_waitcnt lgkmcnt(5)
  v_mfma_f32_32x32x16_bf16 v[144:159], v[160:163], v[64:67], 0
  ds_read_b128 v[184:187], v30 offset:16384
  s_waitcnt lgkmcnt(5)
  v_mfma_f32_32x32x16_bf16 v[144:159], v[164:167], v[68:71], v[144:159]
  ds_read_b128 v[188:191], v31 offset:16384
  s_waitcnt lgkmcnt(5)
  v_mfma_f32_32x32x16_bf16 v[144:159], v[168:171], v[72:75], v[144:159]
  ds_read_b128 v[160:163], v24 offset:16640
  v_mul_f32 v128, s34, v128
  v_mul_f32 v129, s34, v129
  v_cvt_pk_bf16_f32 v192, v128, v129
  s_waitcnt lgkmcnt(5)
  v_mfma_f32_32x32x16_bf16 v[144:159], v[172:175], v[76:79], v[144:159]
  ds_read_b128 v[164:167], v25 offset:16640
  v_mul_f32 v130, s34, v130
  v_mul_f32 v131, s34, v131
  v_cvt_pk_bf16_f32 v193, v130, v131
  s_waitcnt lgkmcnt(5)
  v_mfma_f32_32x32x16_bf16 v[144:159], v[176:179], v[80:83], v[144:159]
  ds_read_b128 v[168:171], v26 offset:16640
  v_mul_f32 v132, s34, v132
  v_mul_f32 v133, s34, v133
  v_cvt_pk_bf16_f32 v194, v132, v133
  s_waitcnt lgkmcnt(5)
  v_mfma_f32_32x32x16_bf16 v[144:159], v[180:183], v[84:87], v[144:159]
  ds_read_b128 v[172:175], v27 offset:16640
  v_mul_f32 v134, s34, v134
  v_mul_f32 v135, s34, v135
  v_cvt_pk_bf16_f32 v195, v134, v135
  s_waitcnt lgkmcnt(5)
  v_mfma_f32_32x32x16_bf16 v[144:159], v[184:187], v[88:91], v[144:159]
  ds_read_b128 v[176:179], v28 offset:16640
  buffer_store_dwordx4 v[192:195], v2, s[8:11], s29 offen offset:0 sc1
  v_mul_f32 v136, s34, v136
  v_mul_f32 v137, s34, v137
  s_waitcnt lgkmcnt(5)
  v_mfma_f32_32x32x16_bf16 v[144:159], v[188:191], v[92:95], v[144:159]
  ds_read_b128 v[180:183], v29 offset:16640
  v_cvt_pk_bf16_f32 v196, v136, v137
  v_mul_f32 v138, s34, v138
  v_mul_f32 v139, s34, v139
  s_waitcnt lgkmcnt(5)
  v_mfma_f32_32x32x16_bf16 v[144:159], v[160:163], v[96:99], v[144:159]
  ds_read_b128 v[184:187], v30 offset:16640
  v_cvt_pk_bf16_f32 v197, v138, v139
  v_mul_f32 v140, s34, v140
  v_mul_f32 v141, s34, v141
  s_waitcnt lgkmcnt(5)
  v_mfma_f32_32x32x16_bf16 v[144:159], v[164:167], v[100:103], v[144:159]
  ds_read_b128 v[188:191], v31 offset:16640
  v_cvt_pk_bf16_f32 v198, v140, v141
  v_mul_f32 v142, s34, v142
  v_mul_f32 v143, s34, v143
  s_waitcnt lgkmcnt(5)
  v_mfma_f32_32x32x16_bf16 v[144:159], v[168:171], v[104:107], v[144:159]
  s_waitcnt vmcnt(23)
  s_barrier
  ds_read_b128 v[160:163], v24 offset:32768
  v_cvt_pk_bf16_f32 v199, v142, v143
  buffer_store_dwordx4 v[196:199], v2, s[8:11], s29 offen offset:1024 sc1
  s_add_u32 s29, s29, 4096
  s_waitcnt lgkmcnt(5)
  v_mfma_f32_32x32x16_bf16 v[144:159], v[172:175], v[108:111], v[144:159]
  ds_read_b128 v[164:167], v25 offset:32768
  s_waitcnt lgkmcnt(5)
  v_mfma_f32_32x32x16_bf16 v[144:159], v[176:179], v[112:115], v[144:159]
  ds_read_b128 v[168:171], v26 offset:32768
  s_waitcnt lgkmcnt(5)
  v_mfma_f32_32x32x16_bf16 v[144:159], v[180:183], v[116:119], v[144:159]
  ds_read_b128 v[172:175], v27 offset:32768
  s_waitcnt lgkmcnt(5)
  v_mfma_f32_32x32x16_bf16 v[144:159], v[184:187], v[120:123], v[144:159]
  ds_read_b128 v[176:179], v28 offset:32768
  s_waitcnt lgkmcnt(5)
  v_mfma_f32_32x32x16_bf16 v[144:159], v[188:191], v[124:127], v[144:159]
  ds_read_b128 v[180:183], v29 offset:32768
  s_waitcnt lgkmcnt(5)
  v_mfma_f32_32x32x16_bf16 v[128:143], v[160:163], v[64:67], 0
  ds_read_b128 v[184:187], v30 offset:32768
  s_waitcnt lgkmcnt(5)
  v_mfma_f32_32x32x16_bf16 v[128:143], v[164:167], v[68:71], v[128:143]
  ds_read_b128 v[188:191], v31 offset:32768
  s_waitcnt lgkmcnt(5)
  v_mfma_f32_32x32x16_bf16 v[128:143], v[168:171], v[72:75], v[128:143]
  ds_read_b128 v[160:163], v24 offset:33024
  v_mul_f32 v144, s34, v144
  v_mul_f32 v145, s34, v145
  v_cvt_pk_bf16_f32 v192, v144, v145
  s_waitcnt lgkmcnt(5)
  v_mfma_f32_32x32x16_bf16 v[128:143], v[172:175], v[76:79], v[128:143]
  ds_read_b128 v[164:167], v25 offset:33024
  v_mul_f32 v146, s34, v146
  v_mul_f32 v147, s34, v147
  v_cvt_pk_bf16_f32 v193, v146, v147
  s_waitcnt lgkmcnt(5)
  v_mfma_f32_32x32x16_bf16 v[128:143], v[176:179], v[80:83], v[128:143]
  ds_read_b128 v[168:171], v26 offset:33024
  v_mul_f32 v148, s34, v148
  v_mul_f32 v149, s34, v149
  v_cvt_pk_bf16_f32 v194, v148, v149
  s_waitcnt lgkmcnt(5)
  v_mfma_f32_32x32x16_bf16 v[128:143], v[180:183], v[84:87], v[128:143]
  ds_read_b128 v[172:175], v27 offset:33024
  v_mul_f32 v150, s34, v150
  v_mul_f32 v151, s34, v151
  v_cvt_pk_bf16_f32 v195, v150, v151
  s_waitcnt lgkmcnt(5)
  v_mfma_f32_32x32x16_bf16 v[128:143], v[184:187], v[88:91], v[128:143]
  ds_read_b128 v[176:179], v28 offset:33024
  buffer_store_dwordx4 v[192:195], v2, s[8:11], s29 offen offset:0 sc1
  v_mul_f32 v152, s34, v152
  v_mul_f32 v153, s34, v153
  s_waitcnt lgkmcnt(5)
  v_mfma_f32_32x32x16_bf16 v[128:143], v[188:191], v[92:95], v[128:143]
  ds_read_b128 v[180:183], v29 offset:33024
  v_cvt_pk_bf16_f32 v196, v152, v153
  v_mul_f32 v154, s34, v154
  v_mul_f32 v155, s34, v155
  s_waitcnt lgkmcnt(5)
  v_mfma_f32_32x32x16_bf16 v[128:143], v[160:163], v[96:99], v[128:143]
  ds_read_b128 v[184:187], v30 offset:33024
  v_cvt_pk_bf16_f32 v197, v154, v155
  v_mul_f32 v156, s34, v156
  v_mul_f32 v157, s34, v157
  s_waitcnt lgkmcnt(5)
  v_mfma_f32_32x32x16_bf16 v[128:143], v[164:167], v[100:103], v[128:143]
  ds_read_b128 v[188:191], v31 offset:33024
  v_cvt_pk_bf16_f32 v198, v156, v157
  v_mul_f32 v158, s34, v158
  v_mul_f32 v159, s34, v159
  s_waitcnt lgkmcnt(5)
  v_mfma_f32_32x32x16_bf16 v[128:143], v[168:171], v[104:107], v[128:143]
  s_waitcnt vmcnt(21)
  s_barrier
  ds_read_b128 v[160:163], v24 offset:49152
  v_cvt_pk_bf16_f32 v199, v158, v159
  buffer_store_dwordx4 v[196:199], v2, s[8:11], s29 offen offset:1024 sc1
  s_add_u32 s29, s29, 4096
  s_waitcnt lgkmcnt(5)
  v_mfma_f32_32x32x16_bf16 v[128:143], v[172:175], v[108:111], v[128:143]
  ds_read_b128 v[164:167], v25 offset:49152
  s_waitcnt lgkmcnt(5)
  v_mfma_f32_32x32x16_bf16 v[128:143], v[176:179], v[112:115], v[128:143]
  ds_read_b128 v[168:171], v26 offset:49152
  s_waitcnt lgkmcnt(5)
  v_mfma_f32_32x32x16_bf16 v[128:143], v[180:183], v[116:119], v[128:143]
  ds_read_b128 v[172:175], v27 offset:49152
  s_waitcnt lgkmcnt(5)
  v_mfma_f32_32x32x16_bf16 v[128:143], v[184:187], v[120:123], v[128:143]
  ds_read_b128 v[176:179], v28 offset:49152
  s_waitcnt lgkmcnt(5)
  v_mfma_f32_32x32x16_bf16 v[128:143], v[188:191], v[124:127], v[128:143]
  ds_read_b128 v[180:183], v29 offset:49152
  s_waitcnt lgkmcnt(5)
  v_mfma_f32_32x32x16_bf16 v[144:159], v[160:163], v[64:67], 0
  ds_read_b128 v[184:187], v30 offset:49152
  s_waitcnt lgkmcnt(5)
  v_mfma_f32_32x32x16_bf16 v[144:159], v[164:167], v[68:71], v[144:159]
  ds_read_b128 v[188:191], v31 offset:49152
  s_waitcnt lgkmcnt(5)
  v_mfma_f32_32x32x16_bf16 v[144:159], v[168:171], v[72:75], v[144:159]
  ds_read_b128 v[160:163], v24 offset:49408
  v_add_u32 v24, 0x10000, v24
  v_mul_f32 v128, s34, v128
  v_mul_f32 v129, s34, v129
  v_cvt_pk_bf16_f32 v192, v128, v129
  s_waitcnt lgkmcnt(5)
  v_mfma_f32_32x32x16_bf16 v[144:159], v[172:175], v[76:79], v[144:159]
  ds_read_b128 v[164:167], v25 offset:49408
  v_add_u32 v25, 0x10000, v25
  v_mul_f32 v130, s34, v130
  v_mul_f32 v131, s34, v131
  v_cvt_pk_bf16_f32 v193, v130, v131
  s_waitcnt lgkmcnt(5)
  v_mfma_f32_32x32x16_bf16 v[144:159], v[176:179], v[80:83], v[144:159]
  ds_read_b128 v[168:171], v26 offset:49408
  v_add_u32 v26, 0x10000, v26
  v_mul_f32 v132, s34, v132
  v_mul_f32 v133, s34, v133
  v_cvt_pk_bf16_f32 v194, v132, v133
  s_waitcnt lgkmcnt(5)
  v_mfma_f32_32x32x16_bf16 v[144:159], v[180:183], v[84:87], v[144:159]
  ds_read_b128 v[172:175], v27 offset:49408
  v_add_u32 v27, 0x10000, v27
  v_mul_f32 v134, s34, v134
  v_mul_f32 v135, s34, v135
  v_cvt_pk_bf16_f32 v195, v134, v135
  s_waitcnt lgkmcnt(5)
  v_mfma_f32_32x32x16_bf16 v[144:159], v[184:187], v[88:91], v[144:159]
  ds_read_b128 v[176:179], v28 offset:49408
  v_add_u32 v28, 0x10000, v28
  buffer_store_dwordx4 v[192:195], v2, s[8:11], s29 offen offset:0 sc1
  v_mul_f32 v136, s34, v136
  v_mul_f32 v137, s34, v137
  s_waitcnt lgkmcnt(5)
  v_mfma_f32_32x32x16_bf16 v[144:159], v[188:191], v[92:95], v[144:159]
  ds_read_b128 v[180:183], v29 offset:49408
  v_add_u32 v29, 0x10000, v29
  v_cvt_pk_bf16_f32 v196, v136, v137
  v_mul_f32 v138, s34, v138
  v_mul_f32 v139, s34, v139
  s_waitcnt lgkmcnt(5)
  v_mfma_f32_32x32x16_bf16 v[144:159], v[160:163], v[96:99], v[144:159]
  ds_read_b128 v[184:187], v30 offset:49408
  v_add_u32 v30, 0x10000, v30
  v_cvt_pk_bf16_f32 v197, v138, v139
  v_mul_f32 v140, s34, v140
  v_mul_f32 v141, s34, v141
  s_waitcnt lgkmcnt(5)
  v_mfma_f32_32x32x16_bf16 v[144:159], v[164:167], v[100:103], v[144:159]
  ds_read_b128 v[188:191], v31 offset:49408
  v_add_u32 v31, 0x10000, v31
  v_cvt_pk_bf16_f32 v198, v140, v141
  v_mul_f32 v142, s34, v142
  v_mul_f32 v143, s34, v143
  s_waitcnt lgkmcnt(5)
  v_mfma_f32_32x32x16_bf16 v[144:159], v[168:171], v[104:107], v[144:159]
  s_waitcnt vmcnt(14)
  s_barrier
  ds_read_b128 v[160:163], v24 offset:0
  v_cvt_pk_bf16_f32 v199, v142, v143
  buffer_store_dwordx4 v[196:199], v2, s[8:11], s29 offen offset:1024 sc1
  s_add_u32 s29, s29, 4096
  s_waitcnt lgkmcnt(5)
  v_mfma_f32_32x32x16_bf16 v[144:159], v[172:175], v[108:111], v[144:159]
  ds_read_b128 v[164:167], v25 offset:0
  s_waitcnt lgkmcnt(5)
  v_mfma_f32_32x32x16_bf16 v[144:159], v[176:179], v[112:115], v[144:159]
  ds_read_b128 v[168:171], v26 offset:0
  s_waitcnt lgkmcnt(5)
  v_mfma_f32_32x32x16_bf16 v[144:159], v[180:183], v[116:119], v[144:159]
  ds_read_b128 v[172:175], v27 offset:0
  s_waitcnt lgkmcnt(5)
  v_mfma_f32_32x32x16_bf16 v[144:159], v[184:187], v[120:123], v[144:159]
  ds_read_b128 v[176:179], v28 offset:0
  s_waitcnt lgkmcnt(5)
  v_mfma_f32_32x32x16_bf16 v[144:159], v[188:191], v[124:127], v[144:159]
  ds_read_b128 v[180:183], v29 offset:0
  s_waitcnt lgkmcnt(5)
  v_mfma_f32_32x32x16_bf16 v[128:143], v[160:163], v[64:67], 0
  ds_read_b128 v[184:187], v30 offset:0
  s_waitcnt lgkmcnt(5)
  v_mfma_f32_32x32x16_bf16 v[128:143], v[164:167], v[68:71], v[128:143]
  ds_read_b128 v[188:191], v31 offset:0
  s_waitcnt lgkmcnt(5)
  v_mfma_f32_32x32x16_bf16 v[128:143], v[168:171], v[72:75], v[128:143]
  ds_read_b128 v[160:163], v24 offset:256
  v_mul_f32 v144, s34, v144
  v_mul_f32 v145, s34, v145
  v_cvt_pk_bf16_f32 v192, v144, v145
  s_waitcnt lgkmcnt(5)
  v_mfma_f32_32x32x16_bf16 v[128:143], v[172:175], v[76:79], v[128:143]
  ds_read_b128 v[164:167], v25 offset:256
  v_mul_f32 v146, s34, v146
  v_mul_f32 v147, s34, v147
  v_cvt_pk_bf16_f32 v193, v146, v147
  s_waitcnt lgkmcnt(5)
  v_mfma_f32_32x32x16_bf16 v[128:143], v[176:179], v[80:83], v[128:143]
  ds_read_b128 v[168:171], v26 offset:256
  v_mul_f32 v148, s34, v148
  v_mul_f32 v149, s34, v149
  v_cvt_pk_bf16_f32 v194, v148, v149
  s_waitcnt lgkmcnt(5)
  v_mfma_f32_32x32x16_bf16 v[128:143], v[180:183], v[84:87], v[128:143]
  ds_read_b128 v[172:175], v27 offset:256
  v_mul_f32 v150, s34, v150
  v_mul_f32 v151, s34, v151
  v_cvt_pk_bf16_f32 v195, v150, v151
  s_waitcnt lgkmcnt(5)
  v_mfma_f32_32x32x16_bf16 v[128:143], v[184:187], v[88:91], v[128:143]
  ds_read_b128 v[176:179], v28 offset:256
  buffer_store_dwordx4 v[192:195], v2, s[8:11], s29 offen offset:0 sc1
  v_mul_f32 v152, s34, v152
  v_mul_f32 v153, s34, v153
  s_waitcnt lgkmcnt(5)
  v_mfma_f32_32x32x16_bf16 v[128:143], v[188:191], v[92:95], v[128:143]
  ds_read_b128 v[180:183], v29 offset:256
  v_cvt_pk_bf16_f32 v196, v152, v153
  v_mul_f32 v154, s34, v154
  v_mul_f32 v155, s34, v155
  s_waitcnt lgkmcnt(5)
  v_mfma_f32_32x32x16_bf16 v[128:143], v[160:163], v[96:99], v[128:143]
  ds_read_b128 v[184:187], v30 offset:256
  v_cvt_pk_bf16_f32 v197, v154, v155
  v_mul_f32 v156, s34, v156
  v_mul_f32 v157, s34, v157
  s_waitcnt lgkmcnt(5)
  v_mfma_f32_32x32x16_bf16 v[128:143], v[164:167], v[100:103], v[128:143]
  ds_read_b128 v[188:191], v31 offset:256
  v_cvt_pk_bf16_f32 v198, v156, v157
  v_mul_f32 v158, s34, v158
  v_mul_f32 v159, s34, v159
  s_waitcnt lgkmcnt(5)
  v_mfma_f32_32x32x16_bf16 v[128:143], v[168:171], v[104:107], v[128:143]
  s_waitcnt vmcnt(12)
  s_cmp_lg_u32 s13, 0
  s_cbranch_scc1 Z_z_ok
  s_waitcnt vmcnt(7)
  s_branch Z_z_chk
Z_z:
  buffer_load_dword v33, v32, s[4:7], 0 offen sc1
  s_waitcnt vmcnt(0)
Z_z_chk:
  v_and_b32 v34, 0xff, v33
  v_cmp_gt_u32 vcc, 32, v34
  s_nop 0
  s_and_b32 vcc_lo, vcc_lo, 0x0
  s_and_b32 vcc_hi, vcc_hi, 0x100
  s_or_b32 vcc_lo, vcc_lo, vcc_hi
  s_cbranch_scc0 Z_z_ok
  s_sub_u32 s25, s25, 1
  s_cbranch_scc1 abort
  s_sleep 8
  s_branch Z_z
Z_z_ok:
  s_barrier
  ds_read_b128 v[160:163], v24 offset:16384
  v_cvt_pk_bf16_f32 v199, v158, v159
  buffer_store_dwordx4 v[196:199], v2, s[8:11], s29 offen offset:1024 sc1
  s_add_u32 s29, s29, 4096
  s_waitcnt lgkmcnt(5)
  v_mfma_f32_32x32x16_bf16 v[128:143], v[172:175], v[108:111], v[128:143]
  ds_read_b128 v[164:167], v25 offset:16384
  s_waitcnt lgkmcnt(5)
  v_mfma_f32_32x32x16_bf16 v[128:143], v[176:179], v[112:115], v[128:143]
  ds_read_b128 v[168:171], v26 offset:16384
  s_waitcnt lgkmcnt(5)
  v_mfma_f32_32x32x16_bf16 v[128:143], v[180:183], v[116:119], v[128:143]
  ds_read_b128 v[172:175], v27 offset:16384
  v_mov_b32 v14, 2
  s_waitcnt vmcnt(4)
  buffer_store_dword v14, v13, s[8:11], s32 offen sc1
  s_waitcnt lgkmcnt(5)
  v_mfma_f32_32x32x16_bf16 v[128:143], v[184:187], v[120:123], v[128:143]
  ds_read_b128 v[176:179], v28 offset:16384
  s_waitcnt lgkmcnt(5)
  v_mfma_f32_32x32x16_bf16 v[128:143], v[188:191], v[124:127], v[128:143]
  ds_read_b128 v[180:183], v29 offset:16384
  s_waitcnt lgkmcnt(5)
  v_mfma_f32_32x32x16_bf16 v[144:159], v[160:163], v[64:67], 0
  ds_read_b128 v[184:187], v30 offset:16384
  s_waitcnt lgkmcnt(5)
  v_mfma_f32_32x32x16_bf16 v[144:159], v[164:167], v[68:71], v[144:159]
  ds_read_b128 v[188:191], v31 offset:16384
  s_waitcnt lgkmcnt(5)
  v_mfma_f32_32x32x16_bf16 v[144:159], v[168:171], v[72:75], v[144:159]
  ds_read_b128 v[160:163], v24 offset:16640
  v_mul_f32 v128, s34, v128
  v_mul_f32 v129, s34, v129
  v_cvt_pk_bf16_f32 v192, v128, v129
  s_waitcnt lgkmcnt(5)
  v_mfma_f32_32x32x16_bf16 v[144:159], v[172:175], v[76:79], v[144:159]
  ds_read_b128 v[164:167], v25 offset:16640
  v_mul_f32 v130, s34, v130
  v_mul_f32 v131, s34, v131
  v_cvt_pk_bf16_f32 v193, v130, v131
  s_waitcnt lgkmcnt(5)
  v_mfma_f32_32x32x16_bf16 v[144:159], v[176:179], v[80:83], v[144:159]
  ds_read_b128 v[168:171], v26 offset:16640
  v_mul_f32 v132, s34, v132
  v_mul_f32 v133, s34, v133
  v_cvt_pk_bf16_f32 v194, v132, v133
  s_waitcnt lgkmcnt(5)
  v_mfma_f32_32x32x16_bf16 v[144:159], v[180:183], v[84:87], v[144:159]
  ds_read_b128 v[172:175], v27 offset:16640
  v_mul_f32 v134, s34, v134
  v_mul_f32 v135, s34, v135
  v_cvt_pk_bf16_f32 v195, v134, v135
  s_waitcnt lgkmcnt(5)
  v_mfma_f32_32x32x16_bf16 v[144:159], v[184:187], v[88:91], v[144:159]
  ds_read_b128 v[176:179], v28 offset:16640
  buffer_store_dwordx4 v[192:195], v2, s[8:11], s29 offen offset:0 sc1
  v_mul_f32 v136, s34, v136
  v_mul_f32 v137, s34, v137
  s_waitcnt lgkmcnt(5)
  v_mfma_f32_32x32x16_bf16 v[144:159], v[188:191], v[92:95], v[144:159]
  ds_read_b128 v[180:183], v29 offset:16640
  v_cvt_pk_bf16_f32 v196, v136, v137
  v_mul_f32 v138, s34, v138
  v_mul_f32 v139, s34, v139
  s_waitcnt lgkmcnt(5)
  v_mfma_f32_32x32x16_bf16 v[144:159], v[160:163], v[96:99], v[144:159]
  ds_read_b128 v[184:187], v30 offset:16640
  v_cvt_pk_bf16_f32 v197, v138, v139
  v_mul_f32 v140, s34, v140
  v_mul_f32 v141, s34, v141
  s_waitcnt lgkmcnt(5)
  v_mfma_f32_32x32x16_bf16 v[144:159], v[164:167], v[100:103], v[144:159]
  ds_read_b128 v[188:191], v31 offset:16640
  v_cvt_pk_bf16_f32 v198, v140, v141
  v_mul_f32 v142, s34, v142
  v_mul_f32 v143, s34, v143
  s_waitcnt lgkmcnt(5)
  v_mfma_f32_32x32x16_bf16 v[144:159], v[168:171], v[104:107], v[144:159]
  s_waitcnt vmcnt(11)
  s_barrier
  ds_read_b128 v[160:163], v24 offset:32768
  v_cvt_pk_bf16_f32 v199, v142, v143
  buffer_store_dwordx4 v[196:199], v2, s[8:11], s29 offen offset:1024 sc1
  s_add_u32 s29, s29, 4096
  s_waitcnt lgkmcnt(5)
  v_mfma_f32_32x32x16_bf16 v[144:159], v[172:175], v[108:111], v[144:159]
  ds_read_b128 v[164:167], v25 offset:32768
  s_waitcnt lgkmcnt(5)
  v_mfma_f32_32x32x16_bf16 v[144:159], v[176:179], v[112:115], v[144:159]
  ds_read_b128 v[168:171], v26 offset:32768
  s_waitcnt lgkmcnt(5)
  v_mfma_f32_32x32x16_bf16 v[144:159], v[180:183], v[116:119], v[144:159]
  ds_read_b128 v[172:175], v27 offset:32768
  s_waitcnt lgkmcnt(5)
  v_mfma_f32_32x32x16_bf16 v[144:159], v[184:187], v[120:123], v[144:159]
  ds_read_b128 v[176:179], v28 offset:32768
  s_waitcnt lgkmcnt(5)
  v_mfma_f32_32x32x16_bf16 v[144:159], v[188:191], v[124:127], v[144:159]
  ds_read_b128 v[180:183], v29 offset:32768
  s_waitcnt lgkmcnt(5)
  v_mfma_f32_32x32x16_bf16 v[128:143], v[160:163], v[64:67], 0
  ds_read_b128 v[184:187], v30 offset:32768
  s_waitcnt lgkmcnt(5)
  v_mfma_f32_32x32x16_bf16 v[128:143], v[164:167], v[68:71], v[128:143]
  ds_read_b128 v[188:191], v31 offset:32768
  s_waitcnt lgkmcnt(5)
  v_mfma_f32_32x32x16_bf16 v[128:143], v[168:171], v[72:75], v[128:143]
  ds_read_b128 v[160:163], v24 offset:33024
  v_mul_f32 v144, s34, v144
  v_mul_f32 v145, s34, v145
  v_cvt_pk_bf16_f32 v192, v144, v145
  s_waitcnt lgkmcnt(5)
  v_mfma_f32_32x32x16_bf16 v[128:143], v[172:175], v[76:79], v[128:143]
  ds_read_b128 v[164:167], v25 offset:33024
  v_mul_f32 v146, s34, v146
  v_mul_f32 v147, s34, v147
  v_cvt_pk_bf16_f32 v193, v146, v147
  s_waitcnt lgkmcnt(5)
  v_mfma_f32_32x32x16_bf16 v[128:143], v[176:179], v[80:83], v[128:143]
  ds_read_b128 v[168:171], v26 offset:33024
  v_mul_f32 v148, s34, v148
  v_mul_f32 v149, s34, v149
  v_cvt_pk_bf16_f32 v194, v148, v149
  s_waitcnt lgkmcnt(5)
  v_mfma_f32_32x32x16_bf16 v[128:143], v[180:183], v[84:87], v[128:143]
  ds_read_b128 v[172:175], v27 offset:33024
  v_mul_f32 v150, s34, v150
  v_mul_f32 v151, s34, v151
  v_cvt_pk_bf16_f32 v195, v150, v151
  s_waitcnt lgkmcnt(5)
  v_mfma_f32_32x32x16_bf16 v[128:143], v[184:187], v[88:91], v[128:143]
  ds_read_b128 v[176:179], v28 offset:33024
  buffer_store_dwordx4 v[192:195], v2, s[8:11], s29 offen offset:0 sc1
  v_mul_f32 v152, s34, v152
  v_mul_f32 v153, s34, v153
  s_waitcnt lgkmcnt(5)
  v_mfma_f32_32x32x16_bf16 v[128:143], v[188:191], v[92:95], v[128:143]
  ds_read_b128 v[180:183], v29 offset:33024
  v_cvt_pk_bf16_f32 v196, v152, v153
  v_mul_f32 v154, s34, v154
  v_mul_f32 v155, s34, v155
  s_waitcnt lgkmcnt(5)
  v_mfma_f32_32x32x16_bf16 v[128:143], v[160:163], v[96:99], v[128:143]
  ds_read_b128 v[184:187], v30 offset:33024
  v_cvt_pk_bf16_f32 v197, v154, v155
  v_mul_f32 v156, s34, v156
  v_mul_f32 v157, s34, v157
  s_waitcnt lgkmcnt(5)
  v_mfma_f32_32x32x16_bf16 v[128:143], v[164:167], v[100:103], v[128:143]
  ds_read_b128 v[188:191], v31 offset:33024
  v_cvt_pk_bf16_f32 v198, v156, v157
  v_mul_f32 v158, s34, v158
  v_mul_f32 v159, s34, v159
  s_waitcnt lgkmcnt(5)
  v_mfma_f32_32x32x16_bf16 v[128:143], v[168:171], v[104:107], v[128:143]
  v_cvt_pk_bf16_f32 v199, v158, v159
  buffer_store_dwordx4 v[196:199], v2, s[8:11], s29 offen offset:1024 sc1
  s_add_u32 s29, s29, 4096
  s_waitcnt lgkmcnt(4)
  v_mfma_f32_32x32x16_bf16 v[128:143], v[172:175], v[108:111], v[128:143]
  s_waitcnt lgkmcnt(3)
  v_mfma_f32_32x32x16_bf16 v[128:143], v[176:179], v[112:115], v[128:143]
  s_waitcnt lgkmcnt(2)
  v_mfma_f32_32x32x16_bf16 v[128:143], v[180:183], v[116:119], v[128:143]
  v_mov_b32 v14, 4
  s_waitcnt vmcnt(5)
  buffer_store_dword v14, v13, s[8:11], s32 offen sc1
  s_waitcnt lgkmcnt(1)
  v_mfma_f32_32x32x16_bf16 v[128:143], v[184:187], v[120:123], v[128:143]
  s_waitcnt lgkmcnt(0)
  v_mfma_f32_32x32x16_bf16 v[128:143], v[188:191], v[124:127], v[128:143]
  s_nop 11
  v_mul_f32 v128, s34, v128
  v_mul_f32 v129, s34, v129
  v_cvt_pk_bf16_f32 v192, v128, v129
  v_mul_f32 v130, s34, v130
  v_mul_f32 v131, s34, v131
  v_cvt_pk_bf16_f32 v193, v130, v131
  v_mul_f32 v132, s34, v132
  v_mul_f32 v133, s34, v133
  v_cvt_pk_bf16_f32 v194, v132, v133
  v_mul_f32 v134, s34, v134
  v_mul_f32 v135, s34, v135
  v_cvt_pk_bf16_f32 v195, v134, v135
  buffer_store_dwordx4 v[192:195], v2, s[8:11], s29 offen offset:0 sc1
  v_mul_f32 v136, s34, v136
  v_mul_f32 v137, s34, v137
  v_cvt_pk_bf16_f32 v196, v136, v137
  v_mul_f32 v138, s34, v138
  v_mul_f32 v139, s34, v139
  v_cvt_pk_bf16_f32 v197, v138, v139
  v_mul_f32 v140, s34, v140
  v_mul_f32 v141, s34, v141
  v_cvt_pk_bf16_f32 v198, v140, v141
  v_mul_f32 v142, s34, v142
  v_mul_f32 v143, s34, v143
  v_cvt_pk_bf16_f32 v199, v142, v143
  buffer_store_dwordx4 v[196:199], v2, s[8:11], s29 offen offset:1024 sc1
  s_add_u32 s29, s29, 4096
  v_mov_b32 v14, 7
  s_mul_i32 s17, s42, 4352
  s_add_u32 s17, s17, 1777664
  s_waitcnt vmcnt(0)
  buffer_store_dword v14, v13, s[8:11], s32 offen sc1
  s_barrier
  buffer_atomic_add v5, v4, s[8:11], s17 offen sc1
  s_lshl_b32 s17, s42, 5
  s_add_u32 s16, s16, s17
  s_sub_u32 s16, s16, 32
  s_cbranch_scc0 T_QU
  s_add_u32 s12, s16, 32
  s_getreg_b32 s17, hwreg(HW_REG_XCC_ID)
  s_and_b32 s17, s17, 7
  s_mul_i32 s18, s17, s17
  s_lshl_b32 s18, s18, 8
  s_add_u32 s17, s17, s18
  s_lshl_b32 s17, s17, 8
  s_add_u32 s15, s17, 1
  v_mov_b32 v14, s15
  buffer_atomic_add v14, v4, s[4:7], 0 offen offset:16 sc1
  s_cmp_lt_u32 s12, 16
  s_cbranch_scc1 roleA
  s_sub_u32 s12, s12, 16
  s_cmp_lt_u32 s12, 14
  s_cbranch_scc1 roleB
  s_sub_u32 s12, s12, 14
  s_branch roleP
W_next:
  s_barrier
  s_cmp_lg_u32 s13, 0
  s_cbranch_scc1 W_bcast
  s_mov_b32 s18, 54272
  v_mov_b32 v7, 1
  s_mov_b64 exec, 1
  buffer_atomic_add v7, v3, s[8:11], s18 offen sc0 sc1
  s_mov_b64 exec, -1
  s_waitcnt vmcnt(0)
  v_readfirstlane_b32 s16, v7
  v_mov_b32 v8, 131072
  s_nop 0
  v_mov_b32 v7, s16
  ds_write_b32 v8, v7
  s_waitcnt lgkmcnt(0)
W_bcast:
  s_barrier
  v_mov_b32 v8, 131072
  ds_read_b32 v7, v8
  s_waitcnt lgkmcnt(0)
  v_readfirstlane_b32 s16, v7
  s_nop 0
  s_cmp_lt_u32 s16, 28
  s_cbranch_scc1 T_T
  s_sub_u32 s16, s16, 28
  s_cmp_lt_u32 s16, 56
  s_cbranch_scc1 T_H
  s_sub_u32 s16, s16, 56
  s_cmp_lt_u32 s16, 64
  s_cbranch_scc1 T_F
  s_sub_u32 s16, s16, 64
  s_cmp_ge_u32 s16, 704
  s_cbranch_scc1 W_quit
  s_mul_i32 s42, s16, 1490
  s_lshr_b32 s42, s42, 16
  s_mul_i32 s17, s42, 44
  s_sub_u32 s16, s16, s17
  s_cmp_lt_u32 s16, 16
  s_cbranch_scc1 T_S
  s_sub_u32 s16, s16, 16
  s_branch T_O
W_quit:
  s_endpgm
abort:
  s_load_dwordx2 s[4:5], s[0:1], 88
  s_mov_b32 s6, 0x100
  s_mov_b32 s7, 0x20000
  v_mov_b32 v2, 0xdead
  v_mov_b32 v3, s16
  v_mov_b32 v0, 0
  s_waitcnt lgkmcnt(0)
  s_mov_b64 exec, 1
  buffer_store_dwordx2 v[2:3], v0, s[4:7], 0 offen sc1
  s_waitcnt vmcnt(0)
  s_endpgm
T_QU:
  s_cmp_lt_u32 s16, 112
  s_cselect_b32 s18, 4, 0
  s_cselect_b32 s17, 0, 112
  s_sub_u32 s16, s16, s17
  s_lshr_b32 s17, s16, 2
  s_lshl_b32 s17, s17, 2
  s_add_u32 s16, s16, s17
  s_add_u32 s16, s16, s18
  s_and_b32 s41, s16, 3
  s_lshr_b32 s17, s16, 3
  s_lshl_b32 s17, s17, 2
  s_add_u32 s17, s17, s13
  s_mov_b32 s50, s17
  s_mul_i32 s18, s17, 4682
  s_lshr_b32 s18, s18, 16
  v_and_b32 v8, 3, v1
  v_add_u32 v8, s17, v8
  v_mul_u32_u24 v8, 4682, v8
  v_lshrrev_b32 v8, 17, v8
  v_lshlrev_b32 v8, 2, v8
  s_bfe_u32 s20, s2, 0x40003
  s_mul_i32 s20, s20, 4352
  s_add_u32 s39, s20, 1812480
  s_mul_i32 s18, s18, 14
  s_add_u32 s18, s18, s17
  s_mul_i32 s26, s18, 28672
  s_lshl_b32 s30, s18, 11
  s_mul_i32 s18, s41, 458752
  s_add_u32 s30, s30, s18
  s_mul_i32 s28, s41, 28672
  s_add_u32 s28, s28, 1884160
  s_mov_b32 s29, 114688
  s_mov_b32 s32, 1835008
  s_lshl_b32 s33, s41, 7
  s_mov_b32 s34, 512
  s_mov_b32 s35, 16
  s_lshl_b32 s40, s17, 10
  s_add_u32 s40, s40, 85835776
  s_cmp_eq_u32 s41, 3
  s_cselect_b32 s40, s40, 0
  s_bitcmp1_b32 s16, 2
  s_cselect_b32 s17, 6422528, 0
  s_cselect_b32 s18, 29360128, 0
  s_cselect_b32 s19, 0, 8192
  s_add_u32 s26, s26, s17
  s_add_u32 s26, s26, 3719168
  s_add_u32 s27, s26, 401408
  s_add_u32 s30, s30, s18
  s_add_u32 s30, s30, 19775488
  s_add_u32 s31, s30, 28672
  s_add_u32 s33, s33, s19
  s_cmp_lg_u32 s13, 0
  s_cbranch_scc1 T_QU_go
  s_bitcmp1_b32 s16, 2
  s_cbranch_scc1 T_QU_w
  s_bfe_u32 s20, s2, 0x40003
  s_mul_i32 s20, s20, 4352
  s_add_u32 s20, s20, 1812480
  v_and_b32 v9, 7, v1
  v_lshl_add_u32 v9, v9, 2, s20
T_QU_cx:
  buffer_load_dword v10, v9, s[8:11], 0 offen sc1
  s_waitcnt vmcnt(0)
T_QU_cx_chk:
  v_cmp_gt_u32 vcc, 32, v10
  s_cbranch_vccz T_QU_cx_ok
  s_sub_u32 s25, s25, 1
  s_cbranch_scc1 abort
  s_sleep 32
  s_branch T_QU_cx
T_QU_cx_ok:
  s_mov_b32 s17, 0
T_QU_q:
  buffer_load_dword v7, v3, s[8:11], s17 offen sc1
  s_waitcnt vmcnt(0)
  v_readfirstlane_b32 s20, v7
  s_nop 0
  s_cmp_ge_u32 s20, 28
  s_cbranch_scc1 T_QU_q_ok
  s_sub_u32 s25, s25, 1
  s_cbranch_scc1 abort
  s_sleep 32
  s_branch T_QU_q
T_QU_q_ok:
  s_branch T_QU_go
T_QU_w:
  buffer_load_dword v9, v8, s[8:11], s39 offen sc1
  s_waitcnt vmcnt(0)
  v_cmp_gt_u32 vcc, 32, v9
  s_cbranch_vccz T_QU_ok
  s_sub_u32 s25, s25, 1
  s_cbranch_scc1 abort
  s_sleep 8
  s_branch T_QU_w
T_QU_ok:
T_QU_go:
  s_barrier
  s_bitcmp1_b32 s16, 2
  s_cbranch_scc1 EU
  s_branch EQ
T_H:
  s_mul_i32 s41, s16, 9363
  s_lshr_b32 s41, s41, 16
  s_mul_i32 s17, s41, 7
  s_sub_u32 s17, s16, s17
  s_lshl_b32 s17, s17, 2
  s_add_u32 s17, s17, s13
  s_mul_i32 s26, s17, 57344
  s_add_u32 s26, s26, 16564224
  s_add_u32 s27, s26, 28672
  s_lshl_b32 s30, s17, 12
  s_mul_i32 s18, s41, 917504
  s_add_u32 s30, s30, s18
  s_add_u32 s30, s30, 78495744
  s_add_u32 s31, s30, 2048
  s_mov_b32 s32, 114688
  s_mul_i32 s28, s41, 229376
  s_add_u32 s28, s28, 1884160
  s_mov_b32 s29, 28672
  s_lshl_b32 s33, s41, 10
  s_add_u32 s33, s33, 16384
  s_mov_b32 s34, 128
  s_mov_b32 s35, 8
  s_mov_b32 s17, 54400
T_H_w:
  buffer_load_dword v7, v3, s[8:11], s17 offen sc1
  s_waitcnt vmcnt(0)
  v_readfirstlane_b32 s20, v7
  s_nop 0
  s_cmp_ge_u32 s20, 28
  s_cbranch_scc1 T_H_w_ok
  s_sub_u32 s25, s25, 1
  s_cbranch_scc1 abort
  s_sleep 4
  s_branch T_H_w
T_H_w_ok:
  s_branch EH
T_F:
  s_lshr_b32 s41, s16, 3
  s_and_b32 s17, s16, 7
  s_mul_i32 s17, s17, 7
  s_lshl_b32 s18, s13, 1
  s_add_u32 s17, s17, s18
  s_mul_i32 s26, s17, 28672
  s_add_u32 s26, s26, 18169856
  s_add_u32 s27, s26, 28672
  s_lshl_b32 s30, s17, 12
  s_mul_i32 s18, s41, 1835008
  s_add_u32 s30, s30, s18
  s_add_u32 s30, s30, 95797248
  s_add_u32 s31, s30, 4096
  s_cmp_eq_u32 s13, 3
  s_cselect_b32 s31, 0x7f000000, s31
  s_cselect_b32 s27, s26, s27
  s_mov_b32 s32, 229376
  s_bfe_u32 s17, s16, 0x20001
  s_lshl_b32 s18, s41, 5
  s_add_u32 s17, s17, s18
  s_mul_i32 s28, s17, 28672
  s_add_u32 s28, s28, 78495744
  s_mov_b32 s29, 114688
  s_lshl_b32 s33, s41, 10
  s_add_u32 s39, s33, 16384
  s_add_u32 s33, s33, 32768
  s_mov_b32 s34, 128
  s_mov_b32 s35, 8
  s_mov_b32 s17, 54400
T_F_w:
  buffer_load_dword v7, v3, s[8:11], s17 offen sc1
  s_waitcnt vmcnt(0)
  v_readfirstlane_b32 s20, v7
  s_nop 0
  s_cmp_ge_u32 s20, 28
  s_cbranch_scc1 T_F_w_ok
  s_sub_u32 s25, s25, 1
  s_cbranch_scc1 abort
  s_sleep 4
  s_branch T_F_w
T_F_w_ok:
  s_branch EF
T_T:
  s_lshl_b32 s17, s16, 2
  s_add_u32 s17, s17, s13
  s_mul_i32 s30, s17, 28672
  s_add_u32 s30, s30, 16564224
  v_lshrrev_b32 v8, 2, v1
  v_and_b32 v9, 3, v1
  s_cmp_ge_u32 s16, 14
  s_cbranch_scc1 T_T2
  s_load_dwordx2 s[4:5], s[0:1], 64
  s_mov_b32 s6, 0x188000
  s_mov_b32 s7, 0x20000
  s_lshl_b32 s28, s17, 6
  s_mov_b32 s29, 3584
  s_branch T_T3
T_T2:
  s_load_dwordx2 s[4:5], s[0:1], 72
  s_mov_b32 s6, 0x188000
  s_mov_b32 s7, 0x20000
  s_sub_u32 s17, s17, 56
  s_mul_i32 s18, s17, 4682
  s_lshr_b32 s18, s18, 16
  s_mul_i32 s19, s18, 14
  s_sub_u32 s17, s17, s19
  s_lshl_b32 s28, s17, 6
  s_mul_i32 s18, s18, 401408
  s_add_u32 s28, s28, s18
  s_mov_b32 s29, 896
T_T3:
  v_mul_lo_u32 v8, v8, s29
  v_lshl_add_u32 v8, v9, 4, v8
  s_lshl_b32 s29, s29, 4
  s_mul_i32 s38, s13, 28672
  s_waitcnt lgkmcnt(0)
  s_add_u32 m0, s38, 0
  s_nop 0
  buffer_load_dwordx4 v8, s[4:7], s28 offen lds
  s_add_u32 s28, s28, s29
  s_add_u32 m0, s38, 1024
  s_nop 0
  buffer_load_dwordx4 v8, s[4:7], s28 offen lds
  s_add_u32 s28, s28, s29
  s_add_u32 m0, s38, 2048
  s_nop 0
  buffer_load_dwordx4 v8, s[4:7], s28 offen lds
  s_add_u32 s28, s28, s29
  s_add_u32 m0, s38, 3072
  s_nop 0
  buffer_load_dwordx4 v8, s[4:7], s28 offen lds
  s_add_u32 s28, s28, s29
  s_add_u32 m0, s38, 4096
  s_nop 0
  buffer_load_dwordx4 v8, s[4:7], s28 offen lds
  s_add_u32 s28, s28, s29
  s_add_u32 m0, s38, 5120
  s_nop 0
  buffer_load_dwordx4 v8, s[4:7], s28 offen lds
  s_add_u32 s28, s28, s29
  s_add_u32 m0, s38, 6144
  s_nop 0
  buffer_load_dwordx4 v8, s[4:7], s28 offen lds
  s_add_u32 s28, s28, s29
  s_add_u32 m0, s38, 7168
  s_nop 0
  buffer_load_dwordx4 v8, s[4:7], s28 offen lds
  s_add_u32 s28, s28, s29
  s_add_u32 m0, s38, 8192
  s_nop 0
  buffer_load_dwordx4 v8, s[4:7], s28 offen lds
  s_add_u32 s28, s28, s29
  s_add_u32 m0, s38, 9216
  s_nop 0
  buffer_load_dwordx4 v8, s[4:7], s28 offen lds
  s_add_u32 s28, s28, s29
  s_add_u32 m0, s38, 10240
  s_nop 0
  buffer_load_dwordx4 v8, s[4:7], s28 offen lds
  s_add_u32 s28, s28, s29
  s_add_u32 m0, s38, 11264
  s_nop 0
  buffer_load_dwordx4 v8, s[4:7], s28 offen lds
  s_add_u32 s28, s28, s29
  s_add_u32 m0, s38, 12288
  s_nop 0
  buffer_load_dwordx4 v8, s[4:7], s28 offen lds
  s_add_u32 s28, s28, s29
  s_add_u32 m0, s38, 13312
  s_nop 0
  buffer_load_dwordx4 v8, s[4:7], s28 offen lds
  s_add_u32 s28, s28, s29
  s_add_u32 m0, s38, 14336
  s_nop 0
  buffer_load_dwordx4 v8, s[4:7], s28 offen lds
  s_add_u32 s28, s28, s29
  s_add_u32 m0, s38, 15360
  s_nop 0
  buffer_load_dwordx4 v8, s[4:7], s28 offen lds
  s_add_u32 s28, s28, s29
  s_add_u32 m0, s38, 16384
  s_nop 0
  buffer_load_dwordx4 v8, s[4:7], s28 offen lds
  s_add_u32 s28, s28, s29
  s_add_u32 m0, s38, 17408
  s_nop 0
  buffer_load_dwordx4 v8, s[4:7], s28 offen lds
  s_add_u32 s28, s28, s29
  s_add_u32 m0, s38, 18432
  s_nop 0
  buffer_load_dwordx4 v8, s[4:7], s28 offen lds
  s_add_u32 s28, s28, s29
  s_add_u32 m0, s38, 19456
  s_nop 0
  buffer_load_dwordx4 v8, s[4:7], s28 offen lds
  s_add_u32 s28, s28, s29
  s_add_u32 m0, s38, 20480
  s_nop 0
  buffer_load_dwordx4 v8, s[4:7], s28 offen lds
  s_add_u32 s28, s28, s29
  s_add_u32 m0, s38, 21504
  s_nop 0
  buffer_load_dwordx4 v8, s[4:7], s28 offen lds
  s_add_u32 s28, s28, s29
  s_add_u32 m0, s38, 22528
  s_nop 0
  buffer_load_dwordx4 v8, s[4:7], s28 offen lds
  s_add_u32 s28, s28, s29
  s_add_u32 m0, s38, 23552
  s_nop 0
  buffer_load_dwordx4 v8, s[4:7], s28 offen lds
  s_add_u32 s28, s28, s29
  s_add_u32 m0, s38, 24576
  s_nop 0
  buffer_load_dwordx4 v8, s[4:7], s28 offen lds
  s_add_u32 s28, s28, s29
  s_add_u32 m0, s38, 25600
  s_nop 0
  buffer_load_dwordx4 v8, s[4:7], s28 offen lds
  s_add_u32 s28, s28, s29
  s_add_u32 m0, s38, 26624
  s_nop 0
  buffer_load_dwordx4 v8, s[4:7], s28 offen lds
  s_add_u32 s28, s28, s29
  s_add_u32 m0, s38, 27648
  s_nop 0
  buffer_load_dwordx4 v8, s[4:7], s28 offen lds
  s_add_u32 s28, s28, s29
  v_bfe_u32 v10, v1, 5, 1
  v_lshlrev_b32 v9, 9, v10
  v_bfe_u32 v10, v1, 2, 2
  v_lshl_or_b32 v9, v10, 6, v9
  v_bfe_u32 v10, v1, 4, 1
  v_lshl_or_b32 v9, v10, 5, v9
  v_and_b32 v10, 1, v1
  v_lshl_or_b32 v9, v10, 4, v9
  v_bfe_u32 v10, v1, 1, 1
  v_lshl_or_b32 v9, v10, 3, v9
  v_add_u32 v9, s38, v9
  s_waitcnt vmcnt(21)
  ds_read_b64_tr_b16 v[16:17], v9 offset:0
  ds_read_b64_tr_b16 v[18:19], v9 offset:256
  ds_read_b64_tr_b16 v[20:21], v9 offset:1024
  ds_read_b64_tr_b16 v[22:23], v9 offset:1280
  ds_read_b64_tr_b16 v[24:25], v9 offset:2048
  ds_read_b64_tr_b16 v[26:27], v9 offset:2304
  ds_read_b64_tr_b16 v[28:29], v9 offset:3072
  ds_read_b64_tr_b16 v[30:31], v9 offset:3328
  ds_read_b64_tr_b16 v[32:33], v9 offset:4096
  ds_read_b64_tr_b16 v[34:35], v9 offset:4352
  ds_read_b64_tr_b16 v[36:37], v9 offset:5120
  ds_read_b64_tr_b16 v[38:39], v9 offset:5376
  ds_read_b64_tr_b16 v[40:41], v9 offset:6144
  ds_read_b64_tr_b16 v[42:43], v9 offset:6400
  s_add_u32 s17, s30, 4096
  s_waitcnt lgkmcnt(12)
  buffer_store_dwordx4 v[16:19], v2, s[8:11], s30 offen offset:0 sc1
  s_waitcnt lgkmcnt(10)
  buffer_store_dwordx4 v[20:23], v2, s[8:11], s30 offen offset:1024 sc1
  s_waitcnt lgkmcnt(8)
  buffer_store_dwordx4 v[24:27], v2, s[8:11], s30 offen offset:2048 sc1
  s_waitcnt lgkmcnt(6)
  buffer_store_dwordx4 v[28:31], v2, s[8:11], s30 offen offset:3072 sc1
  s_waitcnt lgkmcnt(4)
  buffer_store_dwordx4 v[32:35], v2, s[8:11], s17 offen offset:0 sc1
  s_waitcnt lgkmcnt(2)
  buffer_store_dwordx4 v[36:39], v2, s[8:11], s17 offen offset:1024 sc1
  s_waitcnt lgkmcnt(0)
  buffer_store_dwordx4 v[40:43], v2, s[8:11], s17 offen offset:2048 sc1
  s_add_u32 s30, s30, 7168
  s_waitcnt vmcnt(21)
  ds_read_b64_tr_b16 v[44:45], v9 offset:7168
  ds_read_b64_tr_b16 v[46:47], v9 offset:7424
  ds_read_b64_tr_b16 v[48:49], v9 offset:8192
  ds_read_b64_tr_b16 v[50:51], v9 offset:8448
  ds_read_b64_tr_b16 v[52:53], v9 offset:9216
  ds_read_b64_tr_b16 v[54:55], v9 offset:9472
  ds_read_b64_tr_b16 v[56:57], v9 offset:10240
  ds_read_b64_tr_b16 v[58:59], v9 offset:10496
  ds_read_b64_tr_b16 v[60:61], v9 offset:11264
  ds_read_b64_tr_b16 v[62:63], v9 offset:11520
  ds_read_b64_tr_b16 v[64:65], v9 offset:12288
  ds_read_b64_tr_b16 v[66:67], v9 offset:12544
  ds_read_b64_tr_b16 v[68:69], v9 offset:13312
  ds_read_b64_tr_b16 v[70:71], v9 offset:13568
  s_add_u32 s17, s30, 4096
  s_waitcnt lgkmcnt(12)
  buffer_store_dwordx4 v[44:47], v2, s[8:11], s30 offen offset:0 sc1
  s_waitcnt lgkmcnt(10)
  buffer_store_dwordx4 v[48:51], v2, s[8:11], s30 offen offset:1024 sc1
  s_waitcnt lgkmcnt(8)
  buffer_store_dwordx4 v[52:55], v2, s[8:11], s30 offen offset:2048 sc1
  s_waitcnt lgkmcnt(6)
  buffer_store_dwordx4 v[56:59], v2, s[8:11], s30 offen offset:3072 sc1
  s_waitcnt lgkmcnt(4)
  buffer_store_dwordx4 v[60:63], v2, s[8:11], s17 offen offset:0 sc1
  s_waitcnt lgkmcnt(2)
  buffer_store_dwordx4 v[64:67], v2, s[8:11], s17 offen offset:1024 sc1
  s_waitcnt lgkmcnt(0)
  buffer_store_dwordx4 v[68:71], v2, s[8:11], s17 offen offset:2048 sc1
  s_add_u32 s30, s30, 7168
  s_waitcnt vmcnt(21)
  ds_read_b64_tr_b16 v[72:73], v9 offset:14336
  ds_read_b64_tr_b16 v[74:75], v9 offset:14592
  ds_read_b64_tr_b16 v[76:77], v9 offset:15360
  ds_read_b64_tr_b16 v[78:79], v9 offset:15616
  ds_read_b64_tr_b16 v[80:81], v9 offset:16384
  ds_read_b64_tr_b16 v[82:83], v9 offset:16640
  ds_read_b64_tr_b16 v[84:85], v9 offset:17408
  ds_read_b64_tr_b16 v[86:87], v9 offset:17664
  ds_read_b64_tr_b16 v[88:89], v9 offset:18432
  ds_read_b64_tr_b16 v[90:91], v9 offset:18688
  ds_read_b64_tr_b16 v[92:93], v9 offset:19456
  ds_read_b64_tr_b16 v[94:95], v9 offset:19712
  ds_read_b64_tr_b16 v[96:97], v9 offset:20480
  ds_read_b64_tr_b16 v[98:99], v9 offset:20736
  s_add_u32 s17, s30, 4096
  s_waitcnt lgkmcnt(12)
  buffer_store_dwordx4 v[72:75], v2, s[8:11], s30 offen offset:0 sc1
  s_waitcnt lgkmcnt(10)
  buffer_store_dwordx4 v[76:79], v2, s[8:11], s30 offen offset:1024 sc1
  s_waitcnt lgkmcnt(8)
  buffer_store_dwordx4 v[80:83], v2, s[8:11], s30 offen offset:2048 sc1
  s_waitcnt lgkmcnt(6)
  buffer_store_dwordx4 v[84:87], v2, s[8:11], s30 offen offset:3072 sc1
  s_waitcnt lgkmcnt(4)
  buffer_store_dwordx4 v[88:91], v2, s[8:11], s17 offen offset:0 sc1
  s_waitcnt lgkmcnt(2)
  buffer_store_dwordx4 v[92:95], v2, s[8:11], s17 offen offset:1024 sc1
  s_waitcnt lgkmcnt(0)
  buffer_store_dwordx4 v[96:99], v2, s[8:11], s17 offen offset:2048 sc1
  s_add_u32 s30, s30, 7168
  s_waitcnt vmcnt(21)
  ds_read_b64_tr_b16 v[100:101], v9 offset:21504
  ds_read_b64_tr_b16 v[102:103], v9 offset:21760
  ds_read_b64_tr_b16 v[104:105], v9 offset:22528
  ds_read_b64_tr_b16 v[106:107], v9 offset:22784
  ds_read_b64_tr_b16 v[108:109], v9 offset:23552
  ds_read_b64_tr_b16 v[110:111], v9 offset:23808
  ds_read_b64_tr_b16 v[112:113], v9 offset:24576
  ds_read_b64_tr_b16 v[114:115], v9 offset:24832
  ds_read_b64_tr_b16 v[116:117], v9 offset:25600
  ds_read_b64_tr_b16 v[118:119], v9 offset:25856
  ds_read_b64_tr_b16 v[120:121], v9 offset:26624
  ds_read_b64_tr_b16 v[122:123], v9 offset:26880
  ds_read_b64_tr_b16 v[124:125], v9 offset:27648
  ds_read_b64_tr_b16 v[126:127], v9 offset:27904
  s_add_u32 s17, s30, 4096
  s_waitcnt lgkmcnt(12)
  buffer_store_dwordx4 v[100:103], v2, s[8:11], s30 offen offset:0 sc1
  s_waitcnt lgkmcnt(10)
  buffer_store_dwordx4 v[104:107], v2, s[8:11], s30 offen offset:1024 sc1
  s_waitcnt lgkmcnt(8)
  buffer_store_dwordx4 v[108:111], v2, s[8:11], s30 offen offset:2048 sc1
  s_waitcnt lgkmcnt(6)
  buffer_store_dwordx4 v[112:115], v2, s[8:11], s30 offen offset:3072 sc1
  s_waitcnt lgkmcnt(4)
  buffer_store_dwordx4 v[116:119], v2, s[8:11], s17 offen offset:0 sc1
  s_waitcnt lgkmcnt(2)
  buffer_store_dwordx4 v[120:123], v2, s[8:11], s17 offen offset:1024 sc1
  s_waitcnt lgkmcnt(0)
  buffer_store_dwordx4 v[124:127], v2, s[8:11], s17 offen offset:2048 sc1
  s_add_u32 s30, s30, 7168
  s_waitcnt vmcnt(0)
  s_barrier
  s_mov_b32 s17, 54400
  buffer_atomic_add v5, v4, s[8:11], s17 offen sc1
  s_branch W_next
T_S:
  s_lshr_b32 s36, s16, 2
  s_lshl_b32 s41, s42, 2
  s_add_u32 s41, s41, s36
  s_and_b32 s17, s16, 3
  s_lshl_b32 s17, s17, 2
  s_add_u32 s17, s17, s13
  s_lshl_b32 s35, s41, 4
  s_add_u32 s35, s35, s17
  s_mul_i32 s28, s41, 28672
  s_add_u32 s28, s28, 1884160
  buffer_load_dwordx4 a[112:115], v2, s[8:11], s28 offen offset:0
  buffer_load_dwordx4 a[116:119], v2, s[8:11], s28 offen offset:1024
  buffer_load_dwordx4 a[120:123], v2, s[8:11], s28 offen offset:2048
  buffer_load_dwordx4 a[124:127], v2, s[8:11], s28 offen offset:3072
  s_add_u32 s28, s28, 4096
  buffer_load_dwordx4 a[128:131], v2, s[8:11], s28 offen offset:0
  buffer_load_dwordx4 a[132:135], v2, s[8:11], s28 offen offset:1024
  buffer_load_dwordx4 a[136:139], v2, s[8:11], s28 offen offset:2048
  buffer_load_dwordx4 a[140:143], v2, s[8:11], s28 offen offset:3072
  s_add_u32 s28, s28, 4096
  buffer_load_dwordx4 a[144:147], v2, s[8:11], s28 offen offset:0
  buffer_load_dwordx4 a[148:151], v2, s[8:11], s28 offen offset:1024
  buffer_load_dwordx4 a[152:155], v2, s[8:11], s28 offen offset:2048
  buffer_load_dwordx4 a[156:159], v2, s[8:11], s28 offen offset:3072
  s_add_u32 s28, s28, 4096
  buffer_load_dwordx4 a[160:163], v2, s[8:11], s28 offen offset:0
  buffer_load_dwordx4 a[164:167], v2, s[8:11], s28 offen offset:1024
  buffer_load_dwordx4 a[168:171], v2, s[8:11], s28 offen offset:2048
  buffer_load_dwordx4 a[172:175], v2, s[8:11], s28 offen offset:3072
  s_add_u32 s28, s28, 4096
  buffer_load_dwordx4 a[176:179], v2, s[8:11], s28 offen offset:0
  buffer_load_dwordx4 a[180:183], v2, s[8:11], s28 offen offset:1024
  buffer_load_dwordx4 a[184:187], v2, s[8:11], s28 offen offset:2048
  buffer_load_dwordx4 a[188:191], v2, s[8:11], s28 offen offset:3072
  s_add_u32 s28, s28, 4096
  buffer_load_dwordx4 a[192:195], v2, s[8:11], s28 offen offset:0
  buffer_load_dwordx4 a[196:199], v2, s[8:11], s28 offen offset:1024
  buffer_load_dwordx4 a[200:203], v2, s[8:11], s28 offen offset:2048
  buffer_load_dwordx4 a[204:207], v2, s[8:11], s28 offen offset:3072
  s_add_u32 s28, s28, 4096
  buffer_load_dwordx4 a[208:211], v2, s[8:11], s28 offen offset:0
  buffer_load_dwordx4 a[212:215], v2, s[8:11], s28 offen offset:1024
  buffer_load_dwordx4 a[216:219], v2, s[8:11], s28 offen offset:2048
  buffer_load_dwordx4 a[220:223], v2, s[8:11], s28 offen offset:3072
  s_lshl_b32 s33, s41, 7
  s_add_u32 s17, s33, 8192
T_S_q:
  buffer_load_dword v7, v3, s[8:11], s17 offen sc1
  s_waitcnt vmcnt(0)
  v_readfirstlane_b32 s20, v7
  s_nop 0
  s_cmp_ge_u32 s20, 28
  s_cbranch_scc1 T_S_q_ok
  s_sub_u32 s25, s25, 1
  s_cbranch_scc1 abort
  s_sleep 4
  s_branch T_S_q
T_S_q_ok:
  s_mul_i32 s28, s35, 28672
  s_add_u32 s28, s28, 19775488
  buffer_load_dwordx4 a[0:3], v2, s[8:11], s28 offen offset:0 sc1
  buffer_load_dwordx4 a[4:7], v2, s[8:11], s28 offen offset:1024 sc1
  buffer_load_dwordx4 a[8:11], v2, s[8:11], s28 offen offset:2048 sc1
  buffer_load_dwordx4 a[12:15], v2, s[8:11], s28 offen offset:3072 sc1
  s_add_u32 s28, s28, 4096
  buffer_load_dwordx4 a[16:19], v2, s[8:11], s28 offen offset:0 sc1
  buffer_load_dwordx4 a[20:23], v2, s[8:11], s28 offen offset:1024 sc1
  buffer_load_dwordx4 a[24:27], v2, s[8:11], s28 offen offset:2048 sc1
  buffer_load_dwordx4 a[28:31], v2, s[8:11], s28 offen offset:3072 sc1
  s_add_u32 s28, s28, 4096
  buffer_load_dwordx4 a[32:35], v2, s[8:11], s28 offen offset:0 sc1
  buffer_load_dwordx4 a[36:39], v2, s[8:11], s28 offen offset:1024 sc1
  buffer_load_dwordx4 a[40:43], v2, s[8:11], s28 offen offset:2048 sc1
  buffer_load_dwordx4 a[44:47], v2, s[8:11], s28 offen offset:3072 sc1
  s_add_u32 s28, s28, 4096
  buffer_load_dwordx4 a[48:51], v2, s[8:11], s28 offen offset:0 sc1
  buffer_load_dwordx4 a[52:55], v2, s[8:11], s28 offen offset:1024 sc1
  buffer_load_dwordx4 a[56:59], v2, s[8:11], s28 offen offset:2048 sc1
  buffer_load_dwordx4 a[60:63], v2, s[8:11], s28 offen offset:3072 sc1
  s_add_u32 s28, s28, 4096
  buffer_load_dwordx4 a[64:67], v2, s[8:11], s28 offen offset:0 sc1
  buffer_load_dwordx4 a[68:71], v2, s[8:11], s28 offen offset:1024 sc1
  buffer_load_dwordx4 a[72:75], v2, s[8:11], s28 offen offset:2048 sc1
  buffer_load_dwordx4 a[76:79], v2, s[8:11], s28 offen offset:3072 sc1
  s_add_u32 s28, s28, 4096
  buffer_load_dwordx4 a[80:83], v2, s[8:11], s28 offen offset:0 sc1
  buffer_load_dwordx4 a[84:87], v2, s[8:11], s28 offen offset:1024 sc1
  buffer_load_dwordx4 a[88:91], v2, s[8:11], s28 offen offset:2048 sc1
  buffer_load_dwordx4 a[92:95], v2, s[8:11], s28 offen offset:3072 sc1
  s_add_u32 s28, s28, 4096
  buffer_load_dwordx4 a[96:99], v2, s[8:11], s28 offen offset:0 sc1
  buffer_load_dwordx4 a[100:103], v2, s[8:11], s28 offen offset:1024 sc1
  buffer_load_dwordx4 a[104:107], v2, s[8:11], s28 offen offset:2048 sc1
  buffer_load_dwordx4 a[108:111], v2, s[8:11], s28 offen offset:3072 sc1
  v_bfe_u32 v9, v1, 3, 2
  v_lshlrev_b32 v8, 10, v9
  v_lshrrev_b32 v9, 5, v1
  v_lshl_add_u32 v8, v9, 9, v8
  v_and_b32 v10, 7, v1
  v_lshl_add_u32 v8, v10, 4, v8
  s_mul_i32 s28, s42, 28672
  s_lshl_b32 s17, s36, 7
  s_add_u32 s28, s28, s17
  s_add_u32 s28, s28, 1179648
  v_and_b32 v10, 31, v1
  v_lshlrev_b32 v9, 2, v9
  v_sub_u32 v10, v10, v9
  v_mov_b32 v11, 0xff800000
  s_waitcnt vmcnt(27)
  v_mfma_f32_32x32x16_bf16 v[48:63], a[112:115], a[0:3], 0
  s_waitcnt vmcnt(26)
  v_mfma_f32_32x32x16_bf16 v[48:63], a[116:119], a[4:7], v[48:63]
  s_waitcnt vmcnt(25)
  v_mfma_f32_32x32x16_bf16 v[48:63], a[120:123], a[8:11], v[48:63]
  s_waitcnt vmcnt(24)
  v_mfma_f32_32x32x16_bf16 v[48:63], a[124:127], a[12:15], v[48:63]
  s_waitcnt vmcnt(23)
  v_mfma_f32_32x32x16_bf16 v[48:63], a[128:131], a[16:19], v[48:63]
  s_waitcnt vmcnt(22)
  v_mfma_f32_32x32x16_bf16 v[48:63], a[132:135], a[20:23], v[48:63]
  s_waitcnt vmcnt(21)
  v_mfma_f32_32x32x16_bf16 v[48:63], a[136:139], a[24:27], v[48:63]
  s_waitcnt vmcnt(20)
  v_mfma_f32_32x32x16_bf16 v[48:63], a[140:143], a[28:31], v[48:63]
  s_waitcnt vmcnt(19)
  v_mfma_f32_32x32x16_bf16 v[48:63], a[144:147], a[32:35], v[48:63]
  s_waitcnt vmcnt(18)
  v_mfma_f32_32x32x16_bf16 v[48:63], a[148:151], a[36:39], v[48:63]
  s_waitcnt vmcnt(17)
  v_mfma_f32_32x32x16_bf16 v[48:63], a[152:155], a[40:43], v[48:63]
  s_waitcnt vmcnt(16)
  v_mfma_f32_32x32x16_bf16 v[48:63], a[156:159], a[44:47], v[48:63]
  s_waitcnt vmcnt(15)
  v_mfma_f32_32x32x16_bf16 v[48:63], a[160:163], a[48:51], v[48:63]
  s_waitcnt vmcnt(14)
  v_mfma_f32_32x32x16_bf16 v[48:63], a[164:167], a[52:55], v[48:63]
  s_waitcnt vmcnt(13)
  v_mfma_f32_32x32x16_bf16 v[48:63], a[168:171], a[56:59], v[48:63]
  s_waitcnt vmcnt(12)
  v_mfma_f32_32x32x16_bf16 v[48:63], a[172:175], a[60:63], v[48:63]
  s_waitcnt vmcnt(11)
  v_mfma_f32_32x32x16_bf16 v[48:63], a[176:179], a[64:67], v[48:63]
  s_waitcnt vmcnt(10)
  v_mfma_f32_32x32x16_bf16 v[48:63], a[180:183], a[68:71], v[48:63]
  s_waitcnt vmcnt(9)
  v_mfma_f32_32x32x16_bf16 v[48:63], a[184:187], a[72:75], v[48:63]
  s_waitcnt vmcnt(8)
  v_mfma_f32_32x32x16_bf16 v[48:63], a[188:191], a[76:79], v[48:63]
  s_waitcnt vmcnt(7)
  v_mfma_f32_32x32x16_bf16 v[48:63], a[192:195], a[80:83], v[48:63]
  s_waitcnt vmcnt(6)
  v_mfma_f32_32x32x16_bf16 v[48:63], a[196:199], a[84:87], v[48:63]
  s_waitcnt vmcnt(5)
  v_mfma_f32_32x32x16_bf16 v[48:63], a[200:203], a[88:91], v[48:63]
  s_waitcnt vmcnt(4)
  v_mfma_f32_32x32x16_bf16 v[48:63], a[204:207], a[92:95], v[48:63]
  s_waitcnt vmcnt(3)
  v_mfma_f32_32x32x16_bf16 v[48:63], a[208:211], a[96:99], v[48:63]
  s_waitcnt vmcnt(2)
  v_mfma_f32_32x32x16_bf16 v[48:63], a[212:215], a[100:103], v[48:63]
  s_waitcnt vmcnt(1)
  v_mfma_f32_32x32x16_bf16 v[48:63], a[216:219], a[104:107], v[48:63]
  s_waitcnt vmcnt(0)
  v_mfma_f32_32x32x16_bf16 v[48:63], a[220:223], a[108:111], v[48:63]
  v_cmp_le_i32 vcc, 0, v10
  s_nop 10
  v_cndmask_b32 v48, v11, v48, vcc
  v_cmp_le_i32 vcc, 1, v10
  s_nop 1
  v_cndmask_b32 v49, v11, v49, vcc
  v_cmp_le_i32 vcc, 2, v10
  s_nop 1
  v_cndmask_b32 v50, v11, v50, vcc
  v_cmp_le_i32 vcc, 3, v10
  s_nop 1
  v_cndmask_b32 v51, v11, v51, vcc
  v_cmp_le_i32 vcc, 8, v10
  s_nop 1
  v_cndmask_b32 v52, v11, v52, vcc
  v_cmp_le_i32 vcc, 9, v10
  s_nop 1
  v_cndmask_b32 v53, v11, v53, vcc
  v_cmp_le_i32 vcc, 10, v10
  s_nop 1
  v_cndmask_b32 v54, v11, v54, vcc
  v_cmp_le_i32 vcc, 11, v10
  s_nop 1
  v_cndmask_b32 v55, v11, v55, vcc
  v_cmp_le_i32 vcc, 16, v10
  s_nop 1
  v_cndmask_b32 v56, v11, v56, vcc
  v_cmp_le_i32 vcc, 17, v10
  s_nop 1
  v_cndmask_b32 v57, v11, v57, vcc
  v_cmp_le_i32 vcc, 18, v10
  s_nop 1
  v_cndmask_b32 v58, v11, v58, vcc
  v_cmp_le_i32 vcc, 19, v10
  s_nop 1
  v_cndmask_b32 v59, v11, v59, vcc
  v_cmp_le_i32 vcc, 24, v10
  s_nop 1
  v_cndmask_b32 v60, v11, v60, vcc
  v_cmp_le_i32 vcc, 25, v10
  s_nop 1
  v_cndmask_b32 v61, v11, v61, vcc
  v_cmp_le_i32 vcc, 26, v10
  s_nop 1
  v_cndmask_b32 v62, v11, v62, vcc
  v_cmp_le_i32 vcc, 27, v10
  s_nop 1
  v_cndmask_b32 v63, v11, v63, vcc
  v_max3_f32 v128, v48, v49, v50
  v_max3_f32 v128, v128, v51, v52
  v_max3_f32 v128, v128, v53, v54
  v_max3_f32 v128, v128, v55, v56
  v_max3_f32 v128, v128, v57, v58
  v_max3_f32 v128, v128, v59, v60
  v_max3_f32 v128, v128, v61, v62
  v_max_f32 v128, v128, v63
  v_mov_b32 v129, v128
  s_nop 1
  v_permlane32_swap_b32 v128, v129
  v_max_f32 v128, v128, v129
  v_pk_add_f32 v[48:49], v[48:49], v[128:129] op_sel_hi:[1,0] neg_lo:[0,1] neg_hi:[0,1]
  v_exp_f32 v48, v48
  v_exp_f32 v49, v49
  v_pk_add_f32 v[50:51], v[50:51], v[128:129] op_sel_hi:[1,0] neg_lo:[0,1] neg_hi:[0,1]
  v_exp_f32 v50, v50
  v_exp_f32 v51, v51
  v_pk_add_f32 v[52:53], v[52:53], v[128:129] op_sel_hi:[1,0] neg_lo:[0,1] neg_hi:[0,1]
  v_exp_f32 v52, v52
  v_exp_f32 v53, v53
  v_pk_add_f32 v[54:55], v[54:55], v[128:129] op_sel_hi:[1,0] neg_lo:[0,1] neg_hi:[0,1]
  v_exp_f32 v54, v54
  v_exp_f32 v55, v55
  v_pk_add_f32 v[56:57], v[56:57], v[128:129] op_sel_hi:[1,0] neg_lo:[0,1] neg_hi:[0,1]
  v_exp_f32 v56, v56
  v_exp_f32 v57, v57
  v_pk_add_f32 v[58:59], v[58:59], v[128:129] op_sel_hi:[1,0] neg_lo:[0,1] neg_hi:[0,1]
  v_exp_f32 v58, v58
  v_exp_f32 v59, v59
  v_pk_add_f32 v[60:61], v[60:61], v[128:129] op_sel_hi:[1,0] neg_lo:[0,1] neg_hi:[0,1]
  v_exp_f32 v60, v60
  v_exp_f32 v61, v61
  v_pk_add_f32 v[62:63], v[62:63], v[128:129] op_sel_hi:[1,0] neg_lo:[0,1] neg_hi:[0,1]
  v_exp_f32 v62, v62
  v_exp_f32 v63, v63
  v_pk_add_f32 v[130:131], v[48:49], v[50:51]
  v_pk_add_f32 v[130:131], v[130:131], v[52:53]
  v_pk_add_f32 v[130:131], v[130:131], v[54:55]
  v_pk_add_f32 v[130:131], v[130:131], v[56:57]
  v_pk_add_f32 v[130:131], v[130:131], v[58:59]
  v_pk_add_f32 v[130:131], v[130:131], v[60:61]
  v_pk_add_f32 v[130:131], v[130:131], v[62:63]
  v_add_f32 v130, v130, v131
  s_lshl_b32 s30, s35, 11
  s_add_u32 s30, s30, 93175808
  s_lshr_b32 s31, s35, 1
  s_lshl_b32 s31, s31, 10
  s_and_b32 s17, s35, 1
  s_lshl_b32 s17, s17, 3
  s_add_u32 s31, s31, s17
  s_add_u32 s31, s31, 95272960
  s_add_u32 s33, s33, 24576
  s_cmp_eq_u32 s36, 0
  s_cselect_b32 s17, 28160, 0
  s_add_u32 s17, s17, 128
  s_cmp_eq_u32 s41, 0
  s_cselect_b32 s17, 0, s17
  s_sub_u32 s17, s28, s17
  s_add_u32 s17, s17, 27648
  s_cmp_eq_u32 s42, 15
  s_cselect_b32 s37, 2, 0
  s_cbranch_scc1 T_S_m_b
T_S_m_w:
  s_cmp_eq_u32 s37, 1
  s_cbranch_scc1 T_S_m_a
T_S_l:
  buffer_load_dword v7, v3, s[8:11], s17 offen sc1
  s_sub_u32 s25, s25, 1
  s_cbranch_scc1 abort
  s_sleep 8
  s_waitcnt vmcnt(0)
  v_cmp_eq_u32 vcc, -1, v7
  s_cbranch_vccnz T_S_l
  s_mov_b32 s17, s28
  buffer_load_dwordx4 v[16:19], v8, s[8:11], s17 offen sc1
  s_add_u32 s17, s17, 4096
  buffer_load_dwordx4 v[20:23], v8, s[8:11], s17 offen sc1
  s_add_u32 s17, s17, 4096
  buffer_load_dwordx4 v[24:27], v8, s[8:11], s17 offen sc1
  s_add_u32 s17, s17, 4096
  buffer_load_dwordx4 v[28:31], v8, s[8:11], s17 offen sc1
  s_add_u32 s17, s17, 4096
  buffer_load_dwordx4 v[32:35], v8, s[8:11], s17 offen sc1
  s_add_u32 s17, s17, 4096
  buffer_load_dwordx4 v[36:39], v8, s[8:11], s17 offen sc1
  s_add_u32 s17, s17, 4096
  buffer_load_dwordx4 v[40:43], v8, s[8:11], s17 offen sc1
  s_sleep 12
T_S_m:
  s_mov_b32 s17, s28
  buffer_load_dwordx4 v[160:163], v8, s[8:11], s17 offen sc1
  s_add_u32 s17, s17, 4096
  buffer_load_dwordx4 v[164:167], v8, s[8:11], s17 offen sc1
  s_add_u32 s17, s17, 4096
  buffer_load_dwordx4 v[168:171], v8, s[8:11], s17 offen sc1
  s_add_u32 s17, s17, 4096
  buffer_load_dwordx4 v[172:175], v8, s[8:11], s17 offen sc1
  s_add_u32 s17, s17, 4096
  buffer_load_dwordx4 v[176:179], v8, s[8:11], s17 offen sc1
  s_add_u32 s17, s17, 4096
  buffer_load_dwordx4 v[180:183], v8, s[8:11], s17 offen sc1
  s_add_u32 s17, s17, 4096
  buffer_load_dwordx4 v[184:187], v8, s[8:11], s17 offen sc1
  s_waitcnt vmcnt(7)
  v_max3_u32 v7, v16, v17, v20
  v_max3_u32 v7, v7, v21, v24
  v_max3_u32 v7, v7, v25, v28
  v_max3_u32 v7, v7, v29, v32
  v_max3_u32 v7, v7, v33, v36
  v_max3_u32 v7, v7, v37, v40
  v_max_u32 v7, v7, v41
  v_cmp_eq_u32 vcc, -1, v7
  s_cbranch_vccz T_S_m_a
  s_mov_b32 s17, s28
  buffer_load_dwordx4 v[16:19], v8, s[8:11], s17 offen sc1
  s_add_u32 s17, s17, 4096
  buffer_load_dwordx4 v[20:23], v8, s[8:11], s17 offen sc1
  s_add_u32 s17, s17, 4096
  buffer_load_dwordx4 v[24:27], v8, s[8:11], s17 offen sc1
  s_add_u32 s17, s17, 4096
  buffer_load_dwordx4 v[28:31], v8, s[8:11], s17 offen sc1
  s_add_u32 s17, s17, 4096
  buffer_load_dwordx4 v[32:35], v8, s[8:11], s17 offen sc1
  s_add_u32 s17, s17, 4096
  buffer_load_dwordx4 v[36:39], v8, s[8:11], s17 offen sc1
  s_add_u32 s17, s17, 4096
  buffer_load_dwordx4 v[40:43], v8, s[8:11], s17 offen sc1
  s_waitcnt vmcnt(7)
  v_max3_u32 v7, v160, v161, v164
  v_max3_u32 v7, v7, v165, v168
  v_max3_u32 v7, v7, v169, v172
  v_max3_u32 v7, v7, v173, v176
  v_max3_u32 v7, v7, v177, v180
  v_max3_u32 v7, v7, v181, v184
  v_max_u32 v7, v7, v185
  v_cmp_eq_u32 vcc, -1, v7
  s_cbranch_vccz T_S_m_b
  s_sub_u32 s25, s25, 1
  s_cbranch_scc0 T_S_m
  s_branch abort
T_S_m_b:
  v_mfma_f32_32x32x16_bf16 v[64:79], v[160:163], a[0:3], 0
  v_mfma_f32_32x32x16_bf16 v[80:95], v[160:163], a[4:7], 0
  v_mfma_f32_32x32x16_bf16 v[96:111], v[160:163], a[8:11], 0
  v_mfma_f32_32x32x16_bf16 v[112:127], v[160:163], a[12:15], 0
  v_mfma_f32_32x32x16_bf16 v[64:79], v[164:167], a[16:19], v[64:79]
  v_mfma_f32_32x32x16_bf16 v[80:95], v[164:167], a[20:23], v[80:95]
  v_mfma_f32_32x32x16_bf16 v[96:111], v[164:167], a[24:27], v[96:111]
  v_mfma_f32_32x32x16_bf16 v[112:127], v[164:167], a[28:31], v[112:127]
  v_mfma_f32_32x32x16_bf16 v[64:79], v[168:171], a[32:35], v[64:79]
  v_mfma_f32_32x32x16_bf16 v[80:95], v[168:171], a[36:39], v[80:95]
  v_mfma_f32_32x32x16_bf16 v[96:111], v[168:171], a[40:43], v[96:111]
  v_mfma_f32_32x32x16_bf16 v[112:127], v[168:171], a[44:47], v[112:127]
  v_mfma_f32_32x32x16_bf16 v[64:79], v[172:175], a[48:51], v[64:79]
  v_mfma_f32_32x32x16_bf16 v[80:95], v[172:175], a[52:55], v[80:95]
  v_mfma_f32_32x32x16_bf16 v[96:111], v[172:175], a[56:59], v[96:111]
  v_mfma_f32_32x32x16_bf16 v[112:127], v[172:175], a[60:63], v[112:127]
  v_mfma_f32_32x32x16_bf16 v[64:79], v[176:179], a[64:67], v[64:79]
  v_mfma_f32_32x32x16_bf16 v[80:95], v[176:179], a[68:71], v[80:95]
  v_mfma_f32_32x32x16_bf16 v[96:111], v[176:179], a[72:75], v[96:111]
  v_mfma_f32_32x32x16_bf16 v[112:127], v[176:179], a[76:79], v[112:127]
  v_mfma_f32_32x32x16_bf16 v[64:79], v[180:183], a[80:83], v[64:79]
  v_mfma_f32_32x32x16_bf16 v[80:95], v[180:183], a[84:87], v[80:95]
  v_mfma_f32_32x32x16_bf16 v[96:111], v[180:183], a[88:91], v[96:111]
  v_mfma_f32_32x32x16_bf16 v[112:127], v[180:183], a[92:95], v[112:127]
  v_mfma_f32_32x32x16_bf16 v[64:79], v[184:187], a[96:99], v[64:79]
  v_mfma_f32_32x32x16_bf16 v[80:95], v[184:187], a[100:103], v[80:95]
  v_mfma_f32_32x32x16_bf16 v[96:111], v[184:187], a[104:107], v[96:111]
  v_mfma_f32_32x32x16_bf16 v[112:127], v[184:187], a[108:111], v[112:127]
  s_branch T_S_m_ok
T_S_m_a:
  v_mfma_f32_32x32x16_bf16 v[64:79], v[16:19], a[0:3], 0
  v_mfma_f32_32x32x16_bf16 v[80:95], v[16:19], a[4:7], 0
  v_mfma_f32_32x32x16_bf16 v[96:111], v[16:19], a[8:11], 0
  v_mfma_f32_32x32x16_bf16 v[112:127], v[16:19], a[12:15], 0
  v_mfma_f32_32x32x16_bf16 v[64:79], v[20:23], a[16:19], v[64:79]
  v_mfma_f32_32x32x16_bf16 v[80:95], v[20:23], a[20:23], v[80:95]
  v_mfma_f32_32x32x16_bf16 v[96:111], v[20:23], a[24:27], v[96:111]
  v_mfma_f32_32x32x16_bf16 v[112:127], v[20:23], a[28:31], v[112:127]
  v_mfma_f32_32x32x16_bf16 v[64:79], v[24:27], a[32:35], v[64:79]
  v_mfma_f32_32x32x16_bf16 v[80:95], v[24:27], a[36:39], v[80:95]
  v_mfma_f32_32x32x16_bf16 v[96:111], v[24:27], a[40:43], v[96:111]
  v_mfma_f32_32x32x16_bf16 v[112:127], v[24:27], a[44:47], v[112:127]
  v_mfma_f32_32x32x16_bf16 v[64:79], v[28:31], a[48:51], v[64:79]
  v_mfma_f32_32x32x16_bf16 v[80:95], v[28:31], a[52:55], v[80:95]
  v_mfma_f32_32x32x16_bf16 v[96:111], v[28:31], a[56:59], v[96:111]
  v_mfma_f32_32x32x16_bf16 v[112:127], v[28:31], a[60:63], v[112:127]
  v_mfma_f32_32x32x16_bf16 v[64:79], v[32:35], a[64:67], v[64:79]
  v_mfma_f32_32x32x16_bf16 v[80:95], v[32:35], a[68:71], v[80:95]
  v_mfma_f32_32x32x16_bf16 v[96:111], v[32:35], a[72:75], v[96:111]
  v_mfma_f32_32x32x16_bf16 v[112:127], v[32:35], a[76:79], v[112:127]
  v_mfma_f32_32x32x16_bf16 v[64:79], v[36:39], a[80:83], v[64:79]
  v_mfma_f32_32x32x16_bf16 v[80:95], v[36:39], a[84:87], v[80:95]
  v_mfma_f32_32x32x16_bf16 v[96:111], v[36:39], a[88:91], v[96:111]
  v_mfma_f32_32x32x16_bf16 v[112:127], v[36:39], a[92:95], v[112:127]
  v_mfma_f32_32x32x16_bf16 v[64:79], v[40:43], a[96:99], v[64:79]
  v_mfma_f32_32x32x16_bf16 v[80:95], v[40:43], a[100:103], v[80:95]
  v_mfma_f32_32x32x16_bf16 v[96:111], v[40:43], a[104:107], v[96:111]
  v_mfma_f32_32x32x16_bf16 v[112:127], v[40:43], a[108:111], v[112:127]
T_S_m_ok:
  s_sub_u32 s37, s37, 1
  s_cbranch_scc0 T_S_m_w
  v_pk_add_f32 v[64:65], v[64:65], v[84:85]
  v_pk_add_f32 v[66:67], v[66:67], v[86:87]
  s_nop 7
  v_pk_add_f32 v[104:105], v[104:105], v[124:125]
  v_pk_add_f32 v[106:107], v[106:107], v[126:127]
  v_pk_add_f32 v[64:65], v[64:65], v[104:105]
  v_pk_add_f32 v[66:67], v[66:67], v[106:107]
  v_max3_f32 v144, v128, v64, v65
  v_max3_f32 v144, v144, v66, v67
  v_mov_b32 v145, v144
  s_nop 1
  v_permlane32_swap_b32 v144, v145
  v_max_f32 v144, v144, v145
  v_sub_f32 v128, v128, v144
  v_exp_f32 v128, v128
  v_pk_add_f32 v[64:65], v[64:65], v[144:145] op_sel_hi:[1,0] neg_lo:[0,1] neg_hi:[0,1]
  v_exp_f32 v64, v64
  v_exp_f32 v65, v65
  v_pk_add_f32 v[66:67], v[66:67], v[144:145] op_sel_hi:[1,0] neg_lo:[0,1] neg_hi:[0,1]
  v_exp_f32 v66, v66
  v_exp_f32 v67, v67
  s_nop 0
  v_pk_add_f32 v[144:145], v[64:65], v[66:67]
  v_fma_f32 v130, v130, v128, v144
  v_add_f32 v130, v130, v145
  v_mov_b32 v131, v130
  s_nop 1
  v_permlane32_swap_b32 v130, v131
  v_add_f32 v130, v130, v131
  v_rcp_f32 v130, v130
  s_nop 0
  v_mul_f32 v128, v128, v130
  v_pk_mul_f32 v[48:49], v[48:49], v[128:129] op_sel_hi:[1,0]
  v_cvt_pk_bf16_f32 v132, v48, v49
  v_pk_mul_f32 v[50:51], v[50:51], v[128:129] op_sel_hi:[1,0]
  v_cvt_pk_bf16_f32 v133, v50, v51
  v_pk_mul_f32 v[52:53], v[52:53], v[128:129] op_sel_hi:[1,0]
  v_cvt_pk_bf16_f32 v134, v52, v53
  v_pk_mul_f32 v[54:55], v[54:55], v[128:129] op_sel_hi:[1,0]
  v_cvt_pk_bf16_f32 v135, v54, v55
  buffer_store_dwordx4 v[132:135], v2, s[8:11], s30 offen offset:0 sc1
  v_pk_mul_f32 v[56:57], v[56:57], v[128:129] op_sel_hi:[1,0]
  v_cvt_pk_bf16_f32 v136, v56, v57
  v_pk_mul_f32 v[58:59], v[58:59], v[128:129] op_sel_hi:[1,0]
  v_cvt_pk_bf16_f32 v137, v58, v59
  v_pk_mul_f32 v[60:61], v[60:61], v[128:129] op_sel_hi:[1,0]
  v_cvt_pk_bf16_f32 v138, v60, v61
  v_pk_mul_f32 v[62:63], v[62:63], v[128:129] op_sel_hi:[1,0]
  v_cvt_pk_bf16_f32 v139, v62, v63
  buffer_store_dwordx4 v[136:139], v2, s[8:11], s30 offen offset:1024 sc1
  v_pk_mul_f32 v[64:65], v[64:65], v[130:131] op_sel_hi:[1,0]
  v_cvt_pk_bf16_f32 v140, v64, v65
  v_pk_mul_f32 v[66:67], v[66:67], v[130:131] op_sel_hi:[1,0]
  v_cvt_pk_bf16_f32 v141, v66, v67
  buffer_store_dwordx2 v[140:141], v2, s[8:11], s31 offen sc1
  s_waitcnt vmcnt(0)
  s_mov_b64 exec, 1
  buffer_atomic_add v5, v3, s[8:11], s33 offen sc1
  s_mov_b64 exec, -1
  s_branch W_next
T_O:
  s_load_dwordx2 s[4:5], s[0:1], 0
  s_mov_b32 s6, 0x1c0000
  s_mov_b32 s7, 0x20000
  s_mul_i32 s36, s16, 9363
  s_lshr_b32 s36, s36, 16
  s_mul_i32 s17, s36, 7
  s_sub_u32 s35, s16, s17
  s_lshl_b32 s41, s42, 2
  s_add_u32 s41, s41, s36
  s_lshl_b32 s33, s41, 7
  v_and_b32 v8, 31, v1
  v_mul_u32_u24 v8, 896, v8
  v_lshrrev_b32 v9, 5, v1
  v_lshl_add_u32 v8, v9, 4, v8
  s_mul_i32 s30, s41, 28672
  s_lshl_b32 s17, s35, 7
  s_add_u32 s30, s30, s17
  s_lshl_b32 s17, s13, 5
  s_add_u32 s30, s30, s17
  s_waitcnt lgkmcnt(0)
  buffer_load_dwordx4 v[48:51], v8, s[4:7], s30 offen
  s_add_u32 s17, s33, 0
T_O_u:
  buffer_load_dword v7, v3, s[8:11], s17 offen sc1
  s_waitcnt vmcnt(0)
  v_readfirstlane_b32 s20, v7
  s_nop 0
  s_cmp_ge_u32 s20, 28
  s_cbranch_scc1 T_O_u_ok
  s_sub_u32 s25, s25, 1
  s_cbranch_scc1 abort
  s_sleep 4
  s_branch T_O_u
T_O_u_ok:
  s_load_dwordx2 s[4:5], s[0:1], 80
  s_mov_b32 s6, 0x1c0000
  s_mov_b32 s7, 0x20000
  s_lshl_b32 s26, s41, 2
  s_add_u32 s26, s26, s13
  s_mul_i32 s28, s26, 114688
  s_lshl_b32 s17, s35, 12
  s_add_u32 s28, s28, s17
  s_add_u32 s28, s28, 49135616
  buffer_load_dwordx4 a[0:3], v2, s[8:11], s28 offen offset:0 sc1
  buffer_load_dwordx4 a[4:7], v2, s[8:11], s28 offen offset:1024 sc1
  buffer_load_dwordx4 a[8:11], v2, s[8:11], s28 offen offset:2048 sc1
  buffer_load_dwordx4 a[12:15], v2, s[8:11], s28 offen offset:3072 sc1
  s_add_u32 s28, s28, 28672
  buffer_load_dwordx4 a[16:19], v2, s[8:11], s28 offen offset:0 sc1
  buffer_load_dwordx4 a[20:23], v2, s[8:11], s28 offen offset:1024 sc1
  buffer_load_dwordx4 a[24:27], v2, s[8:11], s28 offen offset:2048 sc1
  buffer_load_dwordx4 a[28:31], v2, s[8:11], s28 offen offset:3072 sc1
  s_add_u32 s28, s28, 28672
  buffer_load_dwordx4 a[32:35], v2, s[8:11], s28 offen offset:0 sc1
  buffer_load_dwordx4 a[36:39], v2, s[8:11], s28 offen offset:1024 sc1
  buffer_load_dwordx4 a[40:43], v2, s[8:11], s28 offen offset:2048 sc1
  buffer_load_dwordx4 a[44:47], v2, s[8:11], s28 offen offset:3072 sc1
  s_add_u32 s28, s28, 28672
  buffer_load_dwordx4 a[48:51], v2, s[8:11], s28 offen offset:0 sc1
  buffer_load_dwordx4 a[52:55], v2, s[8:11], s28 offen offset:1024 sc1
  buffer_load_dwordx4 a[56:59], v2, s[8:11], s28 offen offset:2048 sc1
  buffer_load_dwordx4 a[60:63], v2, s[8:11], s28 offen offset:3072 sc1
  s_add_u32 s28, s28, 28672
  s_add_u32 s17, s33, 32768
T_O_f:
  buffer_load_dword v7, v3, s[8:11], s17 offen sc1
  s_waitcnt vmcnt(0)
  v_readfirstlane_b32 s20, v7
  s_nop 0
  s_cmp_ge_u32 s20, 8
  s_cbranch_scc1 T_O_f_ok
  s_sub_u32 s25, s25, 1
  s_cbranch_scc1 abort
  s_sleep 4
  s_branch T_O_f
T_O_f_ok:
  s_mul_i32 s28, s41, 229376
  s_lshl_b32 s17, s35, 13
  s_add_u32 s28, s28, s17
  s_lshl_b32 s17, s13, 11
  s_add_u32 s28, s28, s17
  s_add_u32 s28, s28, 95797248
  buffer_load_dwordx4 v[16:19], v2, s[8:11], s28 offen offset:0 sc1
  buffer_load_dwordx4 v[20:23], v2, s[8:11], s28 offen offset:1024 sc1
  s_add_u32 s28, s28, 57344
  buffer_load_dwordx4 v[24:27], v2, s[8:11], s28 offen offset:0 sc1
  buffer_load_dwordx4 v[28:31], v2, s[8:11], s28 offen offset:1024 sc1
  s_add_u32 s28, s28, 57344
  buffer_load_dwordx4 v[32:35], v2, s[8:11], s28 offen offset:0 sc1
  buffer_load_dwordx4 v[36:39], v2, s[8:11], s28 offen offset:1024 sc1
  s_add_u32 s28, s28, 57344
  buffer_load_dwordx4 v[40:43], v2, s[8:11], s28 offen offset:0 sc1
  buffer_load_dwordx4 v[44:47], v2, s[8:11], s28 offen offset:1024 sc1
  s_add_u32 s28, s28, 57344
  s_lshl_b32 s17, s13, 13
  v_add_u32 v9, s17, v2
  s_lshl_b32 s17, s13, 11
  v_add_u32 v10, s17, v2
  s_waitcnt vmcnt(0)
  v_pk_add_f32 v[16:17], v[16:17], v[24:25]
  v_pk_add_f32 v[32:33], v[32:33], v[40:41]
  v_pk_add_f32 v[16:17], v[16:17], v[32:33]
  v_cvt_pk_bf16_f32 v24, v16, v17
  v_lshlrev_b32 v16, 16, v24
  v_and_b32 v17, 0xffff0000, v24
  v_lshlrev_b32 v52, 16, v48
  v_and_b32 v53, 0xffff0000, v48
  v_pk_add_f32 v[18:19], v[18:19], v[26:27]
  v_pk_add_f32 v[34:35], v[34:35], v[42:43]
  v_pk_add_f32 v[18:19], v[18:19], v[34:35]
  v_cvt_pk_bf16_f32 v25, v18, v19
  v_lshlrev_b32 v18, 16, v25
  v_and_b32 v19, 0xffff0000, v25
  v_lshlrev_b32 v54, 16, v49
  v_and_b32 v55, 0xffff0000, v49
  v_pk_add_f32 v[20:21], v[20:21], v[28:29]
  v_pk_add_f32 v[36:37], v[36:37], v[44:45]
  v_pk_add_f32 v[20:21], v[20:21], v[36:37]
  v_cvt_pk_bf16_f32 v26, v20, v21
  v_lshlrev_b32 v20, 16, v26
  v_and_b32 v21, 0xffff0000, v26
  v_lshlrev_b32 v56, 16, v50
  v_and_b32 v57, 0xffff0000, v50
  v_pk_add_f32 v[22:23], v[22:23], v[30:31]
  v_pk_add_f32 v[38:39], v[38:39], v[46:47]
  v_pk_add_f32 v[22:23], v[22:23], v[38:39]
  v_cvt_pk_bf16_f32 v27, v22, v23
  v_lshlrev_b32 v22, 16, v27
  v_and_b32 v23, 0xffff0000, v27
  v_lshlrev_b32 v58, 16, v51
  v_and_b32 v59, 0xffff0000, v51
  s_lshl_b32 s28, s26, 13
  s_add_u32 s28, s28, 93175808
  s_add_u32 s29, s28, 4096
  s_lshl_b32 s31, s26, 11
  s_add_u32 s31, s31, 95272960
  s_mul_i32 s40, s26, 28672
  s_lshl_b32 s17, s35, 11
  s_add_u32 s40, s40, s17
  s_add_u32 s40, s40, 85835776
  s_add_u32 s32, s40, 14336
  s_cmp_eq_u32 s42, 15
  s_cbranch_scc0 T_O_n
  s_max_u32 s17, s36, 2
  s_lshl_b32 s17, s17, 7
  s_add_u32 s17, s17, 1637376
  s_cmp_eq_u32 s42, 15
  s_cselect_b32 s37, 2, 0
  s_cbranch_scc1 T_O_s_b
T_O_s_w:
  s_cmp_eq_u32 s37, 1
  s_cbranch_scc1 T_O_s_a
T_O_l:
  buffer_load_dword v7, v3, s[8:11], s17 offen sc1
  s_sub_u32 s25, s25, 1
  s_cbranch_scc1 abort
  s_sleep 8
  s_waitcnt vmcnt(0)
  v_cmp_eq_u32 vcc, -1, v7
  s_cbranch_vccnz T_O_l
  buffer_load_dwordx4 v[64:67], v2, s[8:11], s28 offen offset:0 sc1
  buffer_load_dwordx4 v[68:71], v2, s[8:11], s28 offen offset:1024 sc1
  buffer_load_dwordx4 v[72:75], v2, s[8:11], s28 offen offset:2048 sc1
  buffer_load_dwordx4 v[76:79], v2, s[8:11], s28 offen offset:3072 sc1
  buffer_load_dwordx4 v[80:83], v2, s[8:11], s29 offen offset:0 sc1
  buffer_load_dwordx4 v[84:87], v2, s[8:11], s29 offen offset:1024 sc1
  buffer_load_dwordx4 v[88:91], v2, s[8:11], s29 offen offset:2048 sc1
  buffer_load_dwordx4 v[92:95], v2, s[8:11], s29 offen offset:3072 sc1
  buffer_load_dwordx4 v[96:99], v2, s[8:11], s31 offen offset:0 sc1
  buffer_load_dwordx4 v[100:103], v2, s[8:11], s31 offen offset:1024 sc1
  buffer_load_dwordx4 v[104:107], v2, s[8:11], s40 offen offset:0 sc1
  buffer_load_dwordx4 v[108:111], v2, s[8:11], s40 offen offset:1024 sc1
  buffer_load_dwordx4 v[112:115], v2, s[8:11], s32 offen offset:0 sc1
  buffer_load_dwordx4 v[116:119], v2, s[8:11], s32 offen offset:1024 sc1
  s_sleep 12
T_O_s:
  buffer_load_dwordx4 v[192:195], v2, s[8:11], s28 offen offset:0 sc1
  buffer_load_dwordx4 v[196:199], v2, s[8:11], s28 offen offset:1024 sc1
  buffer_load_dwordx4 v[200:203], v2, s[8:11], s28 offen offset:2048 sc1
  buffer_load_dwordx4 v[204:207], v2, s[8:11], s28 offen offset:3072 sc1
  buffer_load_dwordx4 v[208:211], v2, s[8:11], s29 offen offset:0 sc1
  buffer_load_dwordx4 v[212:215], v2, s[8:11], s29 offen offset:1024 sc1
  buffer_load_dwordx4 v[216:219], v2, s[8:11], s29 offen offset:2048 sc1
  buffer_load_dwordx4 v[220:223], v2, s[8:11], s29 offen offset:3072 sc1
  buffer_load_dwordx4 v[224:227], v2, s[8:11], s31 offen offset:0 sc1
  buffer_load_dwordx4 v[228:231], v2, s[8:11], s31 offen offset:1024 sc1
  buffer_load_dwordx4 v[232:235], v2, s[8:11], s40 offen offset:0 sc1
  buffer_load_dwordx4 v[236:239], v2, s[8:11], s40 offen offset:1024 sc1
  buffer_load_dwordx4 v[240:243], v2, s[8:11], s32 offen offset:0 sc1
  buffer_load_dwordx4 v[244:247], v2, s[8:11], s32 offen offset:1024 sc1
  s_waitcnt vmcnt(14)
  v_max3_u32 v7, v64, v68, v72
  v_max3_u32 v7, v7, v76, v80
  v_max3_u32 v7, v7, v84, v88
  v_max3_u32 v7, v7, v92, v96
  v_max3_u32 v7, v7, v100, v104
  v_max3_u32 v7, v7, v108, v112
  v_max3_u32 v7, v7, v116, v98
  v_max_u32 v7, v7, v102
  v_cmp_eq_u32 vcc, -1, v7
  s_cbranch_vccz T_O_s_a
  buffer_load_dwordx4 v[64:67], v2, s[8:11], s28 offen offset:0 sc1
  buffer_load_dwordx4 v[68:71], v2, s[8:11], s28 offen offset:1024 sc1
  buffer_load_dwordx4 v[72:75], v2, s[8:11], s28 offen offset:2048 sc1
  buffer_load_dwordx4 v[76:79], v2, s[8:11], s28 offen offset:3072 sc1
  buffer_load_dwordx4 v[80:83], v2, s[8:11], s29 offen offset:0 sc1
  buffer_load_dwordx4 v[84:87], v2, s[8:11], s29 offen offset:1024 sc1
  buffer_load_dwordx4 v[88:91], v2, s[8:11], s29 offen offset:2048 sc1
  buffer_load_dwordx4 v[92:95], v2, s[8:11], s29 offen offset:3072 sc1
  buffer_load_dwordx4 v[96:99], v2, s[8:11], s31 offen offset:0 sc1
  buffer_load_dwordx4 v[100:103], v2, s[8:11], s31 offen offset:1024 sc1
  buffer_load_dwordx4 v[104:107], v2, s[8:11], s40 offen offset:0 sc1
  buffer_load_dwordx4 v[108:111], v2, s[8:11], s40 offen offset:1024 sc1
  buffer_load_dwordx4 v[112:115], v2, s[8:11], s32 offen offset:0 sc1
  buffer_load_dwordx4 v[116:119], v2, s[8:11], s32 offen offset:1024 sc1
  s_waitcnt vmcnt(14)
  v_max3_u32 v7, v192, v196, v200
  v_max3_u32 v7, v7, v204, v208
  v_max3_u32 v7, v7, v212, v216
  v_max3_u32 v7, v7, v220, v224
  v_max3_u32 v7, v7, v228, v232
  v_max3_u32 v7, v7, v236, v240
  v_max3_u32 v7, v7, v244, v226
  v_max_u32 v7, v7, v230
  v_cmp_eq_u32 vcc, -1, v7
  s_cbranch_vccz T_O_s_b
  s_sub_u32 s25, s25, 1
  s_cbranch_scc0 T_O_s
  s_branch abort
T_O_s_b:
  v_mfma_f32_32x32x16_bf16 v[128:143], a[0:3], v[192:195], 0
  v_mfma_f32_32x32x16_bf16 v[144:159], a[8:11], v[192:195], 0
  v_mfma_f32_32x32x16_bf16 v[128:143], a[4:7], v[196:199], v[128:143]
  v_mfma_f32_32x32x16_bf16 v[144:159], a[12:15], v[196:199], v[144:159]
  v_mfma_f32_32x32x16_bf16 v[128:143], a[16:19], v[200:203], v[128:143]
  v_mfma_f32_32x32x16_bf16 v[144:159], a[24:27], v[200:203], v[144:159]
  v_mfma_f32_32x32x16_bf16 v[128:143], a[20:23], v[204:207], v[128:143]
  v_mfma_f32_32x32x16_bf16 v[144:159], a[28:31], v[204:207], v[144:159]
  v_mfma_f32_32x32x16_bf16 v[128:143], a[32:35], v[208:211], v[128:143]
  v_mfma_f32_32x32x16_bf16 v[144:159], a[40:43], v[208:211], v[144:159]
  v_mfma_f32_32x32x16_bf16 v[128:143], a[36:39], v[212:215], v[128:143]
  v_mfma_f32_32x32x16_bf16 v[144:159], a[44:47], v[212:215], v[144:159]
  v_mfma_f32_32x32x16_bf16 v[128:143], a[48:51], v[216:219], v[128:143]
  v_mfma_f32_32x32x16_bf16 v[144:159], a[56:59], v[216:219], v[144:159]
  v_mfma_f32_32x32x16_bf16 v[128:143], a[52:55], v[220:223], v[128:143]
  v_mfma_f32_32x32x16_bf16 v[144:159], a[60:63], v[220:223], v[144:159]
  v_mfma_f32_32x32x16_bf16 v[128:143], v[232:235], v[224:227], v[128:143]
  v_mfma_f32_32x32x16_bf16 v[144:159], v[236:239], v[224:227], v[144:159]
  v_mfma_f32_32x32x16_bf16 v[128:143], v[240:243], v[228:231], v[128:143]
  v_mfma_f32_32x32x16_bf16 v[144:159], v[244:247], v[228:231], v[144:159]
  s_branch T_O_s_ok
T_O_s_a:
  v_mfma_f32_32x32x16_bf16 v[128:143], a[0:3], v[64:67], 0
  v_mfma_f32_32x32x16_bf16 v[144:159], a[8:11], v[64:67], 0
  v_mfma_f32_32x32x16_bf16 v[128:143], a[4:7], v[68:71], v[128:143]
  v_mfma_f32_32x32x16_bf16 v[144:159], a[12:15], v[68:71], v[144:159]
  v_mfma_f32_32x32x16_bf16 v[128:143], a[16:19], v[72:75], v[128:143]
  v_mfma_f32_32x32x16_bf16 v[144:159], a[24:27], v[72:75], v[144:159]
  v_mfma_f32_32x32x16_bf16 v[128:143], a[20:23], v[76:79], v[128:143]
  v_mfma_f32_32x32x16_bf16 v[144:159], a[28:31], v[76:79], v[144:159]
  v_mfma_f32_32x32x16_bf16 v[128:143], a[32:35], v[80:83], v[128:143]
  v_mfma_f32_32x32x16_bf16 v[144:159], a[40:43], v[80:83], v[144:159]
  v_mfma_f32_32x32x16_bf16 v[128:143], a[36:39], v[84:87], v[128:143]
  v_mfma_f32_32x32x16_bf16 v[144:159], a[44:47], v[84:87], v[144:159]
  v_mfma_f32_32x32x16_bf16 v[128:143], a[48:51], v[88:91], v[128:143]
  v_mfma_f32_32x32x16_bf16 v[144:159], a[56:59], v[88:91], v[144:159]
  v_mfma_f32_32x32x16_bf16 v[128:143], a[52:55], v[92:95], v[128:143]
  v_mfma_f32_32x32x16_bf16 v[144:159], a[60:63], v[92:95], v[144:159]
  v_mfma_f32_32x32x16_bf16 v[128:143], v[104:107], v[96:99], v[128:143]
  v_mfma_f32_32x32x16_bf16 v[144:159], v[108:111], v[96:99], v[144:159]
  v_mfma_f32_32x32x16_bf16 v[128:143], v[112:115], v[100:103], v[128:143]
  v_mfma_f32_32x32x16_bf16 v[144:159], v[116:119], v[100:103], v[144:159]
T_O_s_ok:
  s_sub_u32 s37, s37, 1
  s_cbranch_scc0 T_O_s_w
  s_branch T_O_m
T_O_n:
  s_add_u32 s17, s33, 24576
T_O_p:
  buffer_load_dword v7, v3, s[8:11], s17 offen sc1
  s_waitcnt vmcnt(0)
  v_readfirstlane_b32 s20, v7
  s_nop 0
  s_cmp_ge_u32 s20, 16
  s_cbranch_scc1 T_O_p_ok
  s_sub_u32 s25, s25, 1
  s_cbranch_scc1 abort
  s_sleep 4
  s_branch T_O_p
T_O_p_ok:
  buffer_load_dwordx4 v[64:67], v2, s[8:11], s28 offen offset:0 sc1
  buffer_load_dwordx4 v[68:71], v2, s[8:11], s28 offen offset:1024 sc1
  buffer_load_dwordx4 v[72:75], v2, s[8:11], s28 offen offset:2048 sc1
  buffer_load_dwordx4 v[76:79], v2, s[8:11], s28 offen offset:3072 sc1
  buffer_load_dwordx4 v[80:83], v2, s[8:11], s29 offen offset:0 sc1
  buffer_load_dwordx4 v[84:87], v2, s[8:11], s29 offen offset:1024 sc1
  buffer_load_dwordx4 v[88:91], v2, s[8:11], s29 offen offset:2048 sc1
  buffer_load_dwordx4 v[92:95], v2, s[8:11], s29 offen offset:3072 sc1
  buffer_load_dwordx4 v[96:99], v2, s[8:11], s31 offen offset:0 sc1
  buffer_load_dwordx4 v[100:103], v2, s[8:11], s31 offen offset:1024 sc1
  s_waitcnt vmcnt(9)
  v_mfma_f32_32x32x16_bf16 v[128:143], a[0:3], v[64:67], 0
  v_mfma_f32_32x32x16_bf16 v[144:159], a[8:11], v[64:67], 0
  s_waitcnt vmcnt(8)
  v_mfma_f32_32x32x16_bf16 v[128:143], a[4:7], v[68:71], v[128:143]
  v_mfma_f32_32x32x16_bf16 v[144:159], a[12:15], v[68:71], v[144:159]
  s_waitcnt vmcnt(7)
  v_mfma_f32_32x32x16_bf16 v[128:143], a[16:19], v[72:75], v[128:143]
  v_mfma_f32_32x32x16_bf16 v[144:159], a[24:27], v[72:75], v[144:159]
  s_waitcnt vmcnt(6)
  v_mfma_f32_32x32x16_bf16 v[128:143], a[20:23], v[76:79], v[128:143]
  v_mfma_f32_32x32x16_bf16 v[144:159], a[28:31], v[76:79], v[144:159]
  s_waitcnt vmcnt(5)
  v_mfma_f32_32x32x16_bf16 v[128:143], a[32:35], v[80:83], v[128:143]
  v_mfma_f32_32x32x16_bf16 v[144:159], a[40:43], v[80:83], v[144:159]
  s_waitcnt vmcnt(4)
  v_mfma_f32_32x32x16_bf16 v[128:143], a[36:39], v[84:87], v[128:143]
  v_mfma_f32_32x32x16_bf16 v[144:159], a[44:47], v[84:87], v[144:159]
  s_waitcnt vmcnt(3)
  v_mfma_f32_32x32x16_bf16 v[128:143], a[48:51], v[88:91], v[128:143]
  v_mfma_f32_32x32x16_bf16 v[144:159], a[56:59], v[88:91], v[144:159]
  s_waitcnt vmcnt(2)
  v_mfma_f32_32x32x16_bf16 v[128:143], a[52:55], v[92:95], v[128:143]
  v_mfma_f32_32x32x16_bf16 v[144:159], a[60:63], v[92:95], v[144:159]
  s_lshl_b32 s17, s42, 7
  s_add_u32 s17, s17, 51200
T_O_y:
  buffer_load_dword v7, v3, s[8:11], s17 offen sc1
  s_waitcnt vmcnt(0)
  v_readfirstlane_b32 s20, v7
  s_nop 0
  s_cmp_ge_u32 s20, 28
  s_cbranch_scc1 T_O_y_ok
  s_sub_u32 s25, s25, 1
  s_cbranch_scc1 abort
  s_sleep 4
  s_branch T_O_y
T_O_y_ok:
  buffer_load_dwordx4 v[104:107], v2, s[8:11], s40 offen offset:0 sc1
  buffer_load_dwordx4 v[108:111], v2, s[8:11], s40 offen offset:1024 sc1
  buffer_load_dwordx4 v[112:115], v2, s[8:11], s32 offen offset:0 sc1
  buffer_load_dwordx4 v[116:119], v2, s[8:11], s32 offen offset:1024 sc1
  s_waitcnt vmcnt(3)
  v_mfma_f32_32x32x16_bf16 v[128:143], v[104:107], v[96:99], v[128:143]
  s_waitcnt vmcnt(2)
  v_mfma_f32_32x32x16_bf16 v[144:159], v[108:111], v[96:99], v[144:159]
  s_waitcnt vmcnt(1)
  v_mfma_f32_32x32x16_bf16 v[128:143], v[112:115], v[100:103], v[128:143]
  s_waitcnt vmcnt(0)
  v_mfma_f32_32x32x16_bf16 v[144:159], v[116:119], v[100:103], v[144:159]
T_O_m:
  s_nop 3
  ds_write_b128 v9, v[128:131] offset:0
  ds_write_b128 v9, v[132:135] offset:1024
  ds_write_b128 v9, v[136:139] offset:2048
  ds_write_b128 v9, v[140:143] offset:3072
  s_nop 3
  ds_write_b128 v9, v[144:147] offset:4096
  ds_write_b128 v9, v[148:151] offset:5120
  ds_write_b128 v9, v[152:155] offset:6144
  ds_write_b128 v9, v[156:159] offset:7168
  s_waitcnt lgkmcnt(0)
  s_barrier
  ds_read_b128 v[160:163], v10 offset:0
  ds_read_b128 v[164:167], v10 offset:1024
  ds_read_b128 v[168:171], v10 offset:8192
  ds_read_b128 v[172:175], v10 offset:9216
  ds_read_b128 v[176:179], v10 offset:16384
  ds_read_b128 v[180:183], v10 offset:17408
  ds_read_b128 v[184:187], v10 offset:24576
  ds_read_b128 v[188:191], v10 offset:25600
  s_waitcnt lgkmcnt(0)
  v_pk_add_f32 v[160:161], v[160:161], v[168:169]
  v_pk_add_f32 v[176:177], v[176:177], v[184:185]
  v_pk_add_f32 v[160:161], v[160:161], v[176:177]
  v_cvt_pk_bf16_f32 v168, v160, v161
  v_lshlrev_b32 v160, 16, v168
  v_and_b32 v161, 0xffff0000, v168
  v_pk_add_f32 v[160:161], v[160:161], v[52:53]
  v_cvt_pk_bf16_f32 v168, v160, v161
  v_lshlrev_b32 v160, 16, v168
  v_and_b32 v161, 0xffff0000, v168
  v_pk_add_f32 v[160:161], v[160:161], v[16:17]
  v_cvt_pk_bf16_f32 v48, v160, v161
  v_pk_add_f32 v[162:163], v[162:163], v[170:171]
  v_pk_add_f32 v[178:179], v[178:179], v[186:187]
  v_pk_add_f32 v[162:163], v[162:163], v[178:179]
  v_cvt_pk_bf16_f32 v170, v162, v163
  v_lshlrev_b32 v162, 16, v170
  v_and_b32 v163, 0xffff0000, v170
  v_pk_add_f32 v[162:163], v[162:163], v[54:55]
  v_cvt_pk_bf16_f32 v170, v162, v163
  v_lshlrev_b32 v162, 16, v170
  v_and_b32 v163, 0xffff0000, v170
  v_pk_add_f32 v[162:163], v[162:163], v[18:19]
  v_cvt_pk_bf16_f32 v49, v162, v163
  v_pk_add_f32 v[164:165], v[164:165], v[172:173]
  v_pk_add_f32 v[180:181], v[180:181], v[188:189]
  v_pk_add_f32 v[164:165], v[164:165], v[180:181]
  v_cvt_pk_bf16_f32 v172, v164, v165
  v_lshlrev_b32 v164, 16, v172
  v_and_b32 v165, 0xffff0000, v172
  v_pk_add_f32 v[164:165], v[164:165], v[56:57]
  v_cvt_pk_bf16_f32 v172, v164, v165
  v_lshlrev_b32 v164, 16, v172
  v_and_b32 v165, 0xffff0000, v172
  v_pk_add_f32 v[164:165], v[164:165], v[20:21]
  v_cvt_pk_bf16_f32 v50, v164, v165
  v_pk_add_f32 v[166:167], v[166:167], v[174:175]
  v_pk_add_f32 v[182:183], v[182:183], v[190:191]
  v_pk_add_f32 v[166:167], v[166:167], v[182:183]
  v_cvt_pk_bf16_f32 v174, v166, v167
  v_lshlrev_b32 v166, 16, v174
  v_and_b32 v167, 0xffff0000, v174
  v_pk_add_f32 v[166:167], v[166:167], v[58:59]
  v_cvt_pk_bf16_f32 v174, v166, v167
  v_lshlrev_b32 v166, 16, v174
  v_and_b32 v167, 0xffff0000, v174
  v_pk_add_f32 v[166:167], v[166:167], v[22:23]
  v_cvt_pk_bf16_f32 v51, v166, v167
  buffer_store_dwordx4 v[48:51], v8, s[4:7], s30 offen sc1
  s_cmp_lg_u32 s42, 15
  s_cbranch_scc1 W_next
  s_endpgm
EQ:
  s_add_u32 s17, s26, 0
  buffer_load_dwordx4 a[0:3], v2, s[8:11], s17 offen offset:0
  buffer_load_dwordx4 a[4:7], v2, s[8:11], s17 offen offset:1024
  buffer_load_dwordx4 a[8:11], v2, s[8:11], s17 offen offset:2048
  buffer_load_dwordx4 a[12:15], v2, s[8:11], s17 offen offset:3072
  s_add_u32 s17, s26, 4096
  buffer_load_dwordx4 a[16:19], v2, s[8:11], s17 offen offset:0
  buffer_load_dwordx4 a[20:23], v2, s[8:11], s17 offen offset:1024
  buffer_load_dwordx4 a[24:27], v2, s[8:11], s17 offen offset:2048
  buffer_load_dwordx4 a[28:31], v2, s[8:11], s17 offen offset:3072
  s_add_u32 s17, s26, 8192
  buffer_load_dwordx4 a[32:35], v2, s[8:11], s17 offen offset:0
  buffer_load_dwordx4 a[36:39], v2, s[8:11], s17 offen offset:1024
  buffer_load_dwordx4 a[40:43], v2, s[8:11], s17 offen offset:2048
  buffer_load_dwordx4 a[44:47], v2, s[8:11], s17 offen offset:3072
  s_add_u32 s17, s26, 12288
  buffer_load_dwordx4 a[48:51], v2, s[8:11], s17 offen offset:0
  buffer_load_dwordx4 a[52:55], v2, s[8:11], s17 offen offset:1024
  buffer_load_dwordx4 a[56:59], v2, s[8:11], s17 offen offset:2048
  buffer_load_dwordx4 a[60:63], v2, s[8:11], s17 offen offset:3072
  s_add_u32 s17, s26, 16384
  buffer_load_dwordx4 a[64:67], v2, s[8:11], s17 offen offset:0
  buffer_load_dwordx4 a[68:71], v2, s[8:11], s17 offen offset:1024
  buffer_load_dwordx4 a[72:75], v2, s[8:11], s17 offen offset:2048
  buffer_load_dwordx4 a[76:79], v2, s[8:11], s17 offen offset:3072
  s_add_u32 s17, s26, 20480
  buffer_load_dwordx4 a[80:83], v2, s[8:11], s17 offen offset:0
  buffer_load_dwordx4 a[84:87], v2, s[8:11], s17 offen offset:1024
  buffer_load_dwordx4 a[88:91], v2, s[8:11], s17 offen offset:2048
  buffer_load_dwordx4 a[92:95], v2, s[8:11], s17 offen offset:3072
  s_add_u32 s17, s26, 24576
  buffer_load_dwordx4 a[96:99], v2, s[8:11], s17 offen offset:0
  buffer_load_dwordx4 a[100:103], v2, s[8:11], s17 offen offset:1024
  buffer_load_dwordx4 a[104:107], v2, s[8:11], s17 offen offset:2048
  buffer_load_dwordx4 a[108:111], v2, s[8:11], s17 offen offset:3072
  s_add_u32 s17, s27, 0
  buffer_load_dwordx4 a[112:115], v2, s[8:11], s17 offen offset:0
  buffer_load_dwordx4 a[116:119], v2, s[8:11], s17 offen offset:1024
  buffer_load_dwordx4 a[120:123], v2, s[8:11], s17 offen offset:2048
  buffer_load_dwordx4 a[124:127], v2, s[8:11], s17 offen offset:3072
  s_add_u32 s17, s27, 4096
  buffer_load_dwordx4 a[128:131], v2, s[8:11], s17 offen offset:0
  buffer_load_dwordx4 a[132:135], v2, s[8:11], s17 offen offset:1024
  buffer_load_dwordx4 a[136:139], v2, s[8:11], s17 offen offset:2048
  buffer_load_dwordx4 a[140:143], v2, s[8:11], s17 offen offset:3072
  s_add_u32 s17, s27, 8192
  buffer_load_dwordx4 a[144:147], v2, s[8:11], s17 offen offset:0
  buffer_load_dwordx4 a[148:151], v2, s[8:11], s17 offen offset:1024
  buffer_load_dwordx4 a[152:155], v2, s[8:11], s17 offen offset:2048
  buffer_load_dwordx4 a[156:159], v2, s[8:11], s17 offen offset:3072
  s_add_u32 s17, s27, 12288
  buffer_load_dwordx4 a[160:163], v2, s[8:11], s17 offen offset:0
  buffer_load_dwordx4 a[164:167], v2, s[8:11], s17 offen offset:1024
  buffer_load_dwordx4 a[168:171], v2, s[8:11], s17 offen offset:2048
  buffer_load_dwordx4 a[172:175], v2, s[8:11], s17 offen offset:3072
  s_add_u32 s17, s27, 16384
  buffer_load_dwordx4 a[176:179], v2, s[8:11], s17 offen offset:0
  buffer_load_dwordx4 a[180:183], v2, s[8:11], s17 offen offset:1024
  buffer_load_dwordx4 a[184:187], v2, s[8:11], s17 offen offset:2048
  buffer_load_dwordx4 a[188:191], v2, s[8:11], s17 offen offset:3072
  s_add_u32 s17, s27, 20480
  buffer_load_dwordx4 a[192:195], v2, s[8:11], s17 offen offset:0
  buffer_load_dwordx4 a[196:199], v2, s[8:11], s17 offen offset:1024
  buffer_load_dwordx4 a[200:203], v2, s[8:11], s17 offen offset:2048
  buffer_load_dwordx4 a[204:207], v2, s[8:11], s17 offen offset:3072
  s_add_u32 s17, s27, 24576
  buffer_load_dwordx4 a[208:211], v2, s[8:11], s17 offen offset:0
  buffer_load_dwordx4 a[212:215], v2, s[8:11], s17 offen offset:1024
  buffer_load_dwordx4 a[216:219], v2, s[8:11], s17 offen offset:2048
  buffer_load_dwordx4 a[220:223], v2, s[8:11], s17 offen offset:3072
  s_mul_i32 s38, s13, 7168
  s_add_u32 s28, s28, s38
  s_mov_b32 s37, 0
  s_mov_b32 s36, 0
  s_waitcnt vmcnt(40)
  s_mov_b32 m0, s38
  s_nop 0
  buffer_load_dwordx4 v2, s[8:11], s28 offen offset:0 sc1 lds
  buffer_load_dwordx4 v2, s[8:11], s28 offen offset:1024 sc1 lds
  buffer_load_dwordx4 v2, s[8:11], s28 offen offset:2048 sc1 lds
  buffer_load_dwordx4 v2, s[8:11], s28 offen offset:3072 sc1 lds
  s_add_u32 m0, s38, 4096
  s_add_u32 s17, s28, 4096
  buffer_load_dwordx4 v2, s[8:11], s17 offen offset:0 sc1 lds
  buffer_load_dwordx4 v2, s[8:11], s17 offen offset:1024 sc1 lds
  buffer_load_dwordx4 v2, s[8:11], s17 offen offset:2048 sc1 lds
  s_add_u32 s28, s28, s29
  s_add_u32 s38, s38, 28672
  s_cmp_ge_u32 s38, 86016
  s_cselect_b32 s17, 86016, 0
  s_sub_u32 s38, s38, s17
  s_mov_b32 m0, s38
  s_nop 0
  buffer_load_dwordx4 v2, s[8:11], s28 offen offset:0 sc1 lds
  buffer_load_dwordx4 v2, s[8:11], s28 offen offset:1024 sc1 lds
  buffer_load_dwordx4 v2, s[8:11], s28 offen offset:2048 sc1 lds
  buffer_load_dwordx4 v2, s[8:11], s28 offen offset:3072 sc1 lds
  s_add_u32 m0, s38, 4096
  s_add_u32 s17, s28, 4096
  buffer_load_dwordx4 v2, s[8:11], s17 offen offset:0 sc1 lds
  buffer_load_dwordx4 v2, s[8:11], s17 offen offset:1024 sc1 lds
  buffer_load_dwordx4 v2, s[8:11], s17 offen offset:2048 sc1 lds
  s_add_u32 s28, s28, s29
  s_add_u32 s38, s38, 28672
  s_cmp_ge_u32 s38, 86016
  s_cselect_b32 s17, 86016, 0
  s_sub_u32 s38, s38, s17
EQ_top:
  v_add_u32 v6, s37, v2
  s_waitcnt vmcnt(7)
  s_barrier
  ds_read_b128 v[96:99], v6 offset:0
  ds_read_b128 v[100:103], v6 offset:1024
  ds_read_b128 v[104:107], v6 offset:2048
  ds_read_b128 v[108:111], v6 offset:3072
  ds_read_b128 v[112:115], v6 offset:4096
  ds_read_b128 v[116:119], v6 offset:5120
  s_add_u32 s37, s37, 28672
  s_cmp_ge_u32 s37, 86016
  s_cselect_b32 s37, 0, s37
  s_cmp_lt_u32 s36, 2
  s_cbranch_scc1 EQ_nosig
  buffer_atomic_add v5, v4, s[8:11], s33 offen sc1
  s_add_u32 s33, s33, s34
EQ_nosig:
  s_cmp_lt_u32 s36, 1
  s_cbranch_scc1 EQ_noepi
  v_cvt_pk_bf16_f32 v128, v64, v65
  v_cvt_pk_bf16_f32 v129, v66, v67
  v_cvt_pk_bf16_f32 v130, v68, v69
  v_cvt_pk_bf16_f32 v131, v70, v71
  buffer_store_dwordx4 v[128:131], v2, s[8:11], s30 offen offset:0 sc1
  v_cvt_pk_bf16_f32 v132, v72, v73
  v_cvt_pk_bf16_f32 v133, v74, v75
  v_cvt_pk_bf16_f32 v134, v76, v77
  v_cvt_pk_bf16_f32 v135, v78, v79
  buffer_store_dwordx4 v[132:135], v2, s[8:11], s30 offen offset:1024 sc1
  v_cvt_pk_bf16_f32 v136, v80, v81
  v_cvt_pk_bf16_f32 v137, v82, v83
  v_cvt_pk_bf16_f32 v138, v84, v85
  v_cvt_pk_bf16_f32 v139, v86, v87
  buffer_store_dwordx4 v[136:139], v2, s[8:11], s31 offen offset:0 sc1
  v_cvt_pk_bf16_f32 v140, v88, v89
  v_cvt_pk_bf16_f32 v141, v90, v91
  v_cvt_pk_bf16_f32 v142, v92, v93
  v_cvt_pk_bf16_f32 v143, v94, v95
  buffer_store_dwordx4 v[140:143], v2, s[8:11], s31 offen offset:1024 sc1
  s_add_u32 s30, s30, s32
  s_add_u32 s31, s31, s32
EQ_noepi:
  s_add_u32 s36, s36, 1
  s_waitcnt lgkmcnt(5)
  v_mfma_f32_32x32x16_bf16 v[64:79], a[0:3], v[96:99], 0
  ds_read_b128 v[120:123], v6 offset:6144
  v_mfma_f32_32x32x16_bf16 v[80:95], a[112:115], v[96:99], 0
  s_waitcnt lgkmcnt(5)
  v_mfma_f32_32x32x16_bf16 v[64:79], a[4:7], v[100:103], v[64:79]
  ds_read_b128 v[124:127], v6 offset:7168
  v_mfma_f32_32x32x16_bf16 v[80:95], a[116:119], v[100:103], v[80:95]
  s_mov_b32 m0, s38
  s_nop 0
  buffer_load_dwordx4 v2, s[8:11], s28 offen offset:0 sc1 lds
  s_waitcnt lgkmcnt(5)
  v_mfma_f32_32x32x16_bf16 v[64:79], a[8:11], v[104:107], v[64:79]
  ds_read_b128 v[96:99], v6 offset:8192
  v_mfma_f32_32x32x16_bf16 v[80:95], a[120:123], v[104:107], v[80:95]
  s_waitcnt lgkmcnt(5)
  v_mfma_f32_32x32x16_bf16 v[64:79], a[12:15], v[108:111], v[64:79]
  ds_read_b128 v[100:103], v6 offset:9216
  v_mfma_f32_32x32x16_bf16 v[80:95], a[124:127], v[108:111], v[80:95]
  buffer_load_dwordx4 v2, s[8:11], s28 offen offset:1024 sc1 lds
  s_waitcnt lgkmcnt(5)
  v_mfma_f32_32x32x16_bf16 v[64:79], a[16:19], v[112:115], v[64:79]
  ds_read_b128 v[104:107], v6 offset:10240
  v_mfma_f32_32x32x16_bf16 v[80:95], a[128:131], v[112:115], v[80:95]
  s_waitcnt lgkmcnt(5)
  v_mfma_f32_32x32x16_bf16 v[64:79], a[20:23], v[116:119], v[64:79]
  ds_read_b128 v[108:111], v6 offset:11264
  v_mfma_f32_32x32x16_bf16 v[80:95], a[132:135], v[116:119], v[80:95]
  buffer_load_dwordx4 v2, s[8:11], s28 offen offset:2048 sc1 lds
  s_waitcnt lgkmcnt(5)
  v_mfma_f32_32x32x16_bf16 v[64:79], a[24:27], v[120:123], v[64:79]
  ds_read_b128 v[112:115], v6 offset:12288
  v_mfma_f32_32x32x16_bf16 v[80:95], a[136:139], v[120:123], v[80:95]
  s_waitcnt lgkmcnt(5)
  v_mfma_f32_32x32x16_bf16 v[64:79], a[28:31], v[124:127], v[64:79]
  ds_read_b128 v[116:119], v6 offset:13312
  v_mfma_f32_32x32x16_bf16 v[80:95], a[140:143], v[124:127], v[80:95]
  buffer_load_dwordx4 v2, s[8:11], s28 offen offset:3072 sc1 lds
  s_waitcnt lgkmcnt(5)
  v_mfma_f32_32x32x16_bf16 v[64:79], a[32:35], v[96:99], v[64:79]
  ds_read_b128 v[120:123], v6 offset:14336
  v_mfma_f32_32x32x16_bf16 v[80:95], a[144:147], v[96:99], v[80:95]
  s_waitcnt lgkmcnt(5)
  v_mfma_f32_32x32x16_bf16 v[64:79], a[36:39], v[100:103], v[64:79]
  ds_read_b128 v[124:127], v6 offset:15360
  v_mfma_f32_32x32x16_bf16 v[80:95], a[148:151], v[100:103], v[80:95]
  s_add_u32 m0, s38, 4096
  s_add_u32 s17, s28, 4096
  buffer_load_dwordx4 v2, s[8:11], s17 offen offset:0 sc1 lds
  s_waitcnt lgkmcnt(5)
  v_mfma_f32_32x32x16_bf16 v[64:79], a[40:43], v[104:107], v[64:79]
  ds_read_b128 v[96:99], v6 offset:16384
  v_mfma_f32_32x32x16_bf16 v[80:95], a[152:155], v[104:107], v[80:95]
  s_waitcnt lgkmcnt(5)
  v_mfma_f32_32x32x16_bf16 v[64:79], a[44:47], v[108:111], v[64:79]
  ds_read_b128 v[100:103], v6 offset:17408
  v_mfma_f32_32x32x16_bf16 v[80:95], a[156:159], v[108:111], v[80:95]
  buffer_load_dwordx4 v2, s[8:11], s17 offen offset:1024 sc1 lds
  s_waitcnt lgkmcnt(5)
  v_mfma_f32_32x32x16_bf16 v[64:79], a[48:51], v[112:115], v[64:79]
  ds_read_b128 v[104:107], v6 offset:18432
  v_mfma_f32_32x32x16_bf16 v[80:95], a[160:163], v[112:115], v[80:95]
  s_waitcnt lgkmcnt(5)
  v_mfma_f32_32x32x16_bf16 v[64:79], a[52:55], v[116:119], v[64:79]
  ds_read_b128 v[108:111], v6 offset:19456
  v_mfma_f32_32x32x16_bf16 v[80:95], a[164:167], v[116:119], v[80:95]
  buffer_load_dwordx4 v2, s[8:11], s17 offen offset:2048 sc1 lds
  s_add_u32 s28, s28, s29
  s_add_u32 s38, s38, 28672
  s_cmp_ge_u32 s38, 86016
  s_cselect_b32 s17, 86016, 0
  s_sub_u32 s38, s38, s17
  s_waitcnt lgkmcnt(5)
  v_mfma_f32_32x32x16_bf16 v[64:79], a[56:59], v[120:123], v[64:79]
  ds_read_b128 v[112:115], v6 offset:20480
  v_mfma_f32_32x32x16_bf16 v[80:95], a[168:171], v[120:123], v[80:95]
  s_waitcnt lgkmcnt(5)
  v_mfma_f32_32x32x16_bf16 v[64:79], a[60:63], v[124:127], v[64:79]
  ds_read_b128 v[116:119], v6 offset:21504
  v_mfma_f32_32x32x16_bf16 v[80:95], a[172:175], v[124:127], v[80:95]
  s_waitcnt lgkmcnt(5)
  v_mfma_f32_32x32x16_bf16 v[64:79], a[64:67], v[96:99], v[64:79]
  ds_read_b128 v[120:123], v6 offset:22528
  v_mfma_f32_32x32x16_bf16 v[80:95], a[176:179], v[96:99], v[80:95]
  s_waitcnt lgkmcnt(5)
  v_mfma_f32_32x32x16_bf16 v[64:79], a[68:71], v[100:103], v[64:79]
  ds_read_b128 v[124:127], v6 offset:23552
  v_mfma_f32_32x32x16_bf16 v[80:95], a[180:183], v[100:103], v[80:95]
  s_waitcnt lgkmcnt(5)
  v_mfma_f32_32x32x16_bf16 v[64:79], a[72:75], v[104:107], v[64:79]
  ds_read_b128 v[96:99], v6 offset:24576
  v_mfma_f32_32x32x16_bf16 v[80:95], a[184:187], v[104:107], v[80:95]
  s_waitcnt lgkmcnt(5)
  v_mfma_f32_32x32x16_bf16 v[64:79], a[76:79], v[108:111], v[64:79]
  ds_read_b128 v[100:103], v6 offset:25600
  v_mfma_f32_32x32x16_bf16 v[80:95], a[188:191], v[108:111], v[80:95]
  s_waitcnt lgkmcnt(5)
  v_mfma_f32_32x32x16_bf16 v[64:79], a[80:83], v[112:115], v[64:79]
  ds_read_b128 v[104:107], v6 offset:26624
  v_mfma_f32_32x32x16_bf16 v[80:95], a[192:195], v[112:115], v[80:95]
  s_waitcnt lgkmcnt(5)
  v_mfma_f32_32x32x16_bf16 v[64:79], a[84:87], v[116:119], v[64:79]
  ds_read_b128 v[108:111], v6 offset:27648
  v_mfma_f32_32x32x16_bf16 v[80:95], a[196:199], v[116:119], v[80:95]
  s_waitcnt lgkmcnt(5)
  v_mfma_f32_32x32x16_bf16 v[64:79], a[88:91], v[120:123], v[64:79]
  v_mfma_f32_32x32x16_bf16 v[80:95], a[200:203], v[120:123], v[80:95]
  s_waitcnt lgkmcnt(4)
  v_mfma_f32_32x32x16_bf16 v[64:79], a[92:95], v[124:127], v[64:79]
  v_mfma_f32_32x32x16_bf16 v[80:95], a[204:207], v[124:127], v[80:95]
  s_waitcnt lgkmcnt(3)
  v_mfma_f32_32x32x16_bf16 v[64:79], a[96:99], v[96:99], v[64:79]
  v_mfma_f32_32x32x16_bf16 v[80:95], a[208:211], v[96:99], v[80:95]
  s_waitcnt lgkmcnt(2)
  v_mfma_f32_32x32x16_bf16 v[64:79], a[100:103], v[100:103], v[64:79]
  v_mfma_f32_32x32x16_bf16 v[80:95], a[212:215], v[100:103], v[80:95]
  s_waitcnt lgkmcnt(1)
  v_mfma_f32_32x32x16_bf16 v[64:79], a[104:107], v[104:107], v[64:79]
  v_mfma_f32_32x32x16_bf16 v[80:95], a[216:219], v[104:107], v[80:95]
  s_waitcnt lgkmcnt(0)
  v_mfma_f32_32x32x16_bf16 v[64:79], a[108:111], v[108:111], v[64:79]
  v_mfma_f32_32x32x16_bf16 v[80:95], a[220:223], v[108:111], v[80:95]
  s_cmp_lt_u32 s36, s35
  s_cbranch_scc1 EQ_top
  s_nop 1
  v_cvt_pk_bf16_f32 v128, v64, v65
  v_cvt_pk_bf16_f32 v129, v66, v67
  v_cvt_pk_bf16_f32 v130, v68, v69
  v_cvt_pk_bf16_f32 v131, v70, v71
  buffer_store_dwordx4 v[128:131], v2, s[8:11], s30 offen offset:0 sc1
  v_cvt_pk_bf16_f32 v132, v72, v73
  v_cvt_pk_bf16_f32 v133, v74, v75
  v_cvt_pk_bf16_f32 v134, v76, v77
  v_cvt_pk_bf16_f32 v135, v78, v79
  buffer_store_dwordx4 v[132:135], v2, s[8:11], s30 offen offset:1024 sc1
  v_cvt_pk_bf16_f32 v136, v80, v81
  v_cvt_pk_bf16_f32 v137, v82, v83
  v_cvt_pk_bf16_f32 v138, v84, v85
  v_cvt_pk_bf16_f32 v139, v86, v87
  buffer_store_dwordx4 v[136:139], v2, s[8:11], s31 offen offset:0 sc1
  v_cvt_pk_bf16_f32 v140, v88, v89
  v_cvt_pk_bf16_f32 v141, v90, v91
  v_cvt_pk_bf16_f32 v142, v92, v93
  v_cvt_pk_bf16_f32 v143, v94, v95
  buffer_store_dwordx4 v[140:143], v2, s[8:11], s31 offen offset:1024 sc1
  s_add_u32 s30, s30, s32
  s_add_u32 s31, s31, s32
  s_waitcnt vmcnt(0)
  s_barrier
  buffer_atomic_add v5, v4, s[8:11], s33 offen sc1
  s_add_u32 s33, s33, s34
  buffer_atomic_add v5, v4, s[8:11], s33 offen sc1
  s_branch W_next
EU:
  s_add_u32 s17, s26, 0
  buffer_load_dwordx4 a[0:3], v2, s[8:11], s17 offen offset:0
  buffer_load_dwordx4 a[4:7], v2, s[8:11], s17 offen offset:1024
  buffer_load_dwordx4 a[8:11], v2, s[8:11], s17 offen offset:2048
  buffer_load_dwordx4 a[12:15], v2, s[8:11], s17 offen offset:3072
  s_add_u32 s17, s26, 4096
  buffer_load_dwordx4 a[16:19], v2, s[8:11], s17 offen offset:0
  buffer_load_dwordx4 a[20:23], v2, s[8:11], s17 offen offset:1024
  buffer_load_dwordx4 a[24:27], v2, s[8:11], s17 offen offset:2048
  buffer_load_dwordx4 a[28:31], v2, s[8:11], s17 offen offset:3072
  s_add_u32 s17, s26, 8192
  buffer_load_dwordx4 a[32:35], v2, s[8:11], s17 offen offset:0
  buffer_load_dwordx4 a[36:39], v2, s[8:11], s17 offen offset:1024
  buffer_load_dwordx4 a[40:43], v2, s[8:11], s17 offen offset:2048
  buffer_load_dwordx4 a[44:47], v2, s[8:11], s17 offen offset:3072
  s_add_u32 s17, s26, 12288
  buffer_load_dwordx4 a[48:51], v2, s[8:11], s17 offen offset:0
  buffer_load_dwordx4 a[52:55], v2, s[8:11], s17 offen offset:1024
  buffer_load_dwordx4 a[56:59], v2, s[8:11], s17 offen offset:2048
  buffer_load_dwordx4 a[60:63], v2, s[8:11], s17 offen offset:3072
  s_add_u32 s17, s26, 16384
  buffer_load_dwordx4 a[64:67], v2, s[8:11], s17 offen offset:0
  buffer_load_dwordx4 a[68:71], v2, s[8:11], s17 offen offset:1024
  buffer_load_dwordx4 a[72:75], v2, s[8:11], s17 offen offset:2048
  buffer_load_dwordx4 a[76:79], v2, s[8:11], s17 offen offset:3072
  s_add_u32 s17, s26, 20480
  buffer_load_dwordx4 a[80:83], v2, s[8:11], s17 offen offset:0
  buffer_load_dwordx4 a[84:87], v2, s[8:11], s17 offen offset:1024
  buffer_load_dwordx4 a[88:91], v2, s[8:11], s17 offen offset:2048
  buffer_load_dwordx4 a[92:95], v2, s[8:11], s17 offen offset:3072
  s_add_u32 s17, s26, 24576
  buffer_load_dwordx4 a[96:99], v2, s[8:11], s17 offen offset:0
  buffer_load_dwordx4 a[100:103], v2, s[8:11], s17 offen offset:1024
  buffer_load_dwordx4 a[104:107], v2, s[8:11], s17 offen offset:2048
  buffer_load_dwordx4 a[108:111], v2, s[8:11], s17 offen offset:3072
  s_bfe_u32 s20, s2, 0x40003
  s_mul_i32 s20, s20, 4352
  s_add_u32 s20, s20, 1812480
  v_and_b32 v9, 7, v1
  v_lshl_add_u32 v9, v9, 2, s20
  buffer_load_dword v10, v9, s[8:11], 0 offen sc1
  s_add_u32 s17, s27, 0
  buffer_load_dwordx4 a[112:115], v2, s[8:11], s17 offen offset:0
  buffer_load_dwordx4 a[116:119], v2, s[8:11], s17 offen offset:1024
  buffer_load_dwordx4 a[120:123], v2, s[8:11], s17 offen offset:2048
  buffer_load_dwordx4 a[124:127], v2, s[8:11], s17 offen offset:3072
  s_add_u32 s17, s27, 4096
  buffer_load_dwordx4 a[128:131], v2, s[8:11], s17 offen offset:0
  buffer_load_dwordx4 a[132:135], v2, s[8:11], s17 offen offset:1024
  buffer_load_dwordx4 a[136:139], v2, s[8:11], s17 offen offset:2048
  buffer_load_dwordx4 a[140:143], v2, s[8:11], s17 offen offset:3072
  s_add_u32 s17, s27, 8192
  buffer_load_dwordx4 a[144:147], v2, s[8:11], s17 offen offset:0
  buffer_load_dwordx4 a[148:151], v2, s[8:11], s17 offen offset:1024
  buffer_load_dwordx4 a[152:155], v2, s[8:11], s17 offen offset:2048
  buffer_load_dwordx4 a[156:159], v2, s[8:11], s17 offen offset:3072
  s_add_u32 s17, s27, 12288
  buffer_load_dwordx4 a[160:163], v2, s[8:11], s17 offen offset:0
  buffer_load_dwordx4 a[164:167], v2, s[8:11], s17 offen offset:1024
  buffer_load_dwordx4 a[168:171], v2, s[8:11], s17 offen offset:2048
  buffer_load_dwordx4 a[172:175], v2, s[8:11], s17 offen offset:3072
  s_add_u32 s17, s27, 16384
  buffer_load_dwordx4 a[176:179], v2, s[8:11], s17 offen offset:0
  buffer_load_dwordx4 a[180:183], v2, s[8:11], s17 offen offset:1024
  buffer_load_dwordx4 a[184:187], v2, s[8:11], s17 offen offset:2048
  buffer_load_dwordx4 a[188:191], v2, s[8:11], s17 offen offset:3072
  s_add_u32 s17, s27, 20480
  buffer_load_dwordx4 a[192:195], v2, s[8:11], s17 offen offset:0
  buffer_load_dwordx4 a[196:199], v2, s[8:11], s17 offen offset:1024
  buffer_load_dwordx4 a[200:203], v2, s[8:11], s17 offen offset:2048
  buffer_load_dwordx4 a[204:207], v2, s[8:11], s17 offen offset:3072
  s_add_u32 s17, s27, 24576
  buffer_load_dwordx4 a[208:211], v2, s[8:11], s17 offen offset:0
  buffer_load_dwordx4 a[212:215], v2, s[8:11], s17 offen offset:1024
  buffer_load_dwordx4 a[216:219], v2, s[8:11], s17 offen offset:2048
  buffer_load_dwordx4 a[220:223], v2, s[8:11], s17 offen offset:3072
  s_mul_i32 s38, s13, 7168
  s_add_u32 s28, s28, s38
  s_mov_b32 s37, 0
  s_mov_b32 s36, 0
  s_waitcnt vmcnt(28)
  s_branch EU_cx_chk
EU_cx:
  buffer_load_dword v10, v9, s[8:11], 0 offen sc1
  s_waitcnt vmcnt(0)
EU_cx_chk:
  v_cmp_gt_u32 vcc, 32, v10
  s_cbranch_vccz EU_cx_ok
  s_sub_u32 s25, s25, 1
  s_cbranch_scc1 abort
  s_sleep 8
  s_branch EU_cx
EU_cx_ok:
  s_mov_b32 m0, s38
  s_nop 0
  buffer_load_dwordx4 v2, s[8:11], s28 offen offset:0 sc1 lds
  buffer_load_dwordx4 v2, s[8:11], s28 offen offset:1024 sc1 lds
  buffer_load_dwordx4 v2, s[8:11], s28 offen offset:2048 sc1 lds
  buffer_load_dwordx4 v2, s[8:11], s28 offen offset:3072 sc1 lds
  s_add_u32 m0, s38, 4096
  s_add_u32 s17, s28, 4096
  buffer_load_dwordx4 v2, s[8:11], s17 offen offset:0 sc1 lds
  buffer_load_dwordx4 v2, s[8:11], s17 offen offset:1024 sc1 lds
  buffer_load_dwordx4 v2, s[8:11], s17 offen offset:2048 sc1 lds
  s_add_u32 s28, s28, s29
  s_add_u32 s38, s38, 28672
  s_cmp_ge_u32 s38, 86016
  s_cselect_b32 s17, 86016, 0
  s_sub_u32 s38, s38, s17
  s_mov_b32 m0, s38
  s_nop 0
  buffer_load_dwordx4 v2, s[8:11], s28 offen offset:0 sc1 lds
  buffer_load_dwordx4 v2, s[8:11], s28 offen offset:1024 sc1 lds
  buffer_load_dwordx4 v2, s[8:11], s28 offen offset:2048 sc1 lds
  buffer_load_dwordx4 v2, s[8:11], s28 offen offset:3072 sc1 lds
  s_add_u32 m0, s38, 4096
  s_add_u32 s17, s28, 4096
  buffer_load_dwordx4 v2, s[8:11], s17 offen offset:0 sc1 lds
  buffer_load_dwordx4 v2, s[8:11], s17 offen offset:1024 sc1 lds
  buffer_load_dwordx4 v2, s[8:11], s17 offen offset:2048 sc1 lds
  s_add_u32 s28, s28, s29
  s_add_u32 s38, s38, 28672
  s_cmp_ge_u32 s38, 86016
  s_cselect_b32 s17, 86016, 0
  s_sub_u32 s38, s38, s17
EU_top:
  v_add_u32 v6, s37, v2
  s_waitcnt vmcnt(7)
  s_barrier
  ds_read_b128 v[96:99], v6 offset:0
  ds_read_b128 v[100:103], v6 offset:1024
  ds_read_b128 v[104:107], v6 offset:2048
  ds_read_b128 v[108:111], v6 offset:3072
  ds_read_b128 v[112:115], v6 offset:4096
  ds_read_b128 v[116:119], v6 offset:5120
  s_add_u32 s37, s37, 28672
  s_cmp_ge_u32 s37, 86016
  s_cselect_b32 s37, 0, s37
  s_cmp_lt_u32 s36, 2
  s_cbranch_scc1 EU_nosig
  buffer_atomic_add v5, v4, s[8:11], s33 offen sc1
  s_add_u32 s33, s33, s34
EU_nosig:
  s_cmp_lt_u32 s36, 1
  s_cbranch_scc1 EU_noepi
  v_cvt_pk_bf16_f32 v128, v64, v65
  v_cvt_pk_bf16_f32 v129, v66, v67
  v_cvt_pk_bf16_f32 v130, v68, v69
  v_cvt_pk_bf16_f32 v131, v70, v71
  buffer_store_dwordx4 v[128:131], v2, s[8:11], s30 offen offset:0 sc1
  v_cvt_pk_bf16_f32 v132, v72, v73
  v_cvt_pk_bf16_f32 v133, v74, v75
  v_cvt_pk_bf16_f32 v134, v76, v77
  v_cvt_pk_bf16_f32 v135, v78, v79
  buffer_store_dwordx4 v[132:135], v2, s[8:11], s30 offen offset:1024 sc1
  v_cvt_pk_bf16_f32 v136, v80, v81
  v_cvt_pk_bf16_f32 v137, v82, v83
  v_cvt_pk_bf16_f32 v138, v84, v85
  v_cvt_pk_bf16_f32 v139, v86, v87
  buffer_store_dwordx4 v[136:139], v2, s[8:11], s31 offen offset:0 sc1
  v_cvt_pk_bf16_f32 v140, v88, v89
  v_cvt_pk_bf16_f32 v141, v90, v91
  v_cvt_pk_bf16_f32 v142, v92, v93
  v_cvt_pk_bf16_f32 v143, v94, v95
  buffer_store_dwordx4 v[140:143], v2, s[8:11], s31 offen offset:1024 sc1
  s_add_u32 s30, s30, s32
  s_add_u32 s31, s31, s32
EU_noepi:
  s_add_u32 s36, s36, 1
  s_waitcnt lgkmcnt(5)
  v_mfma_f32_32x32x16_bf16 v[64:79], v[96:99], a[0:3], 0
  ds_read_b128 v[120:123], v6 offset:6144
  v_mfma_f32_32x32x16_bf16 v[80:95], v[96:99], a[112:115], 0
  s_waitcnt lgkmcnt(5)
  v_mfma_f32_32x32x16_bf16 v[64:79], v[100:103], a[4:7], v[64:79]
  ds_read_b128 v[124:127], v6 offset:7168
  v_mfma_f32_32x32x16_bf16 v[80:95], v[100:103], a[116:119], v[80:95]
  s_mov_b32 m0, s38
  s_nop 0
  buffer_load_dwordx4 v2, s[8:11], s28 offen offset:0 sc1 lds
  s_waitcnt lgkmcnt(5)
  v_mfma_f32_32x32x16_bf16 v[64:79], v[104:107], a[8:11], v[64:79]
  ds_read_b128 v[96:99], v6 offset:8192
  v_mfma_f32_32x32x16_bf16 v[80:95], v[104:107], a[120:123], v[80:95]
  s_waitcnt lgkmcnt(5)
  v_mfma_f32_32x32x16_bf16 v[64:79], v[108:111], a[12:15], v[64:79]
  ds_read_b128 v[100:103], v6 offset:9216
  v_mfma_f32_32x32x16_bf16 v[80:95], v[108:111], a[124:127], v[80:95]
  buffer_load_dwordx4 v2, s[8:11], s28 offen offset:1024 sc1 lds
  s_waitcnt lgkmcnt(5)
  v_mfma_f32_32x32x16_bf16 v[64:79], v[112:115], a[16:19], v[64:79]
  ds_read_b128 v[104:107], v6 offset:10240
  v_mfma_f32_32x32x16_bf16 v[80:95], v[112:115], a[128:131], v[80:95]
  s_waitcnt lgkmcnt(5)
  v_mfma_f32_32x32x16_bf16 v[64:79], v[116:119], a[20:23], v[64:79]
  ds_read_b128 v[108:111], v6 offset:11264
  v_mfma_f32_32x32x16_bf16 v[80:95], v[116:119], a[132:135], v[80:95]
  buffer_load_dwordx4 v2, s[8:11], s28 offen offset:2048 sc1 lds
  s_waitcnt lgkmcnt(5)
  v_mfma_f32_32x32x16_bf16 v[64:79], v[120:123], a[24:27], v[64:79]
  ds_read_b128 v[112:115], v6 offset:12288
  v_mfma_f32_32x32x16_bf16 v[80:95], v[120:123], a[136:139], v[80:95]
  s_waitcnt lgkmcnt(5)
  v_mfma_f32_32x32x16_bf16 v[64:79], v[124:127], a[28:31], v[64:79]
  ds_read_b128 v[116:119], v6 offset:13312
  v_mfma_f32_32x32x16_bf16 v[80:95], v[124:127], a[140:143], v[80:95]
  buffer_load_dwordx4 v2, s[8:11], s28 offen offset:3072 sc1 lds
  s_waitcnt lgkmcnt(5)
  v_mfma_f32_32x32x16_bf16 v[64:79], v[96:99], a[32:35], v[64:79]
  ds_read_b128 v[120:123], v6 offset:14336
  v_mfma_f32_32x32x16_bf16 v[80:95], v[96:99], a[144:147], v[80:95]
  s_waitcnt lgkmcnt(5)
  v_mfma_f32_32x32x16_bf16 v[64:79], v[100:103], a[36:39], v[64:79]
  ds_read_b128 v[124:127], v6 offset:15360
  v_mfma_f32_32x32x16_bf16 v[80:95], v[100:103], a[148:151], v[80:95]
  s_add_u32 m0, s38, 4096
  s_add_u32 s17, s28, 4096
  buffer_load_dwordx4 v2, s[8:11], s17 offen offset:0 sc1 lds
  s_waitcnt lgkmcnt(5)
  v_mfma_f32_32x32x16_bf16 v[64:79], v[104:107], a[40:43], v[64:79]
  ds_read_b128 v[96:99], v6 offset:16384
  v_mfma_f32_32x32x16_bf16 v[80:95], v[104:107], a[152:155], v[80:95]
  s_waitcnt lgkmcnt(5)
  v_mfma_f32_32x32x16_bf16 v[64:79], v[108:111], a[44:47], v[64:79]
  ds_read_b128 v[100:103], v6 offset:17408
  v_mfma_f32_32x32x16_bf16 v[80:95], v[108:111], a[156:159], v[80:95]
  buffer_load_dwordx4 v2, s[8:11], s17 offen offset:1024 sc1 lds
  s_waitcnt lgkmcnt(5)
  v_mfma_f32_32x32x16_bf16 v[64:79], v[112:115], a[48:51], v[64:79]
  ds_read_b128 v[104:107], v6 offset:18432
  v_mfma_f32_32x32x16_bf16 v[80:95], v[112:115], a[160:163], v[80:95]
  s_waitcnt lgkmcnt(5)
  v_mfma_f32_32x32x16_bf16 v[64:79], v[116:119], a[52:55], v[64:79]
  ds_read_b128 v[108:111], v6 offset:19456
  v_mfma_f32_32x32x16_bf16 v[80:95], v[116:119], a[164:167], v[80:95]
  buffer_load_dwordx4 v2, s[8:11], s17 offen offset:2048 sc1 lds
  s_add_u32 s28, s28, s29
  s_add_u32 s38, s38, 28672
  s_cmp_ge_u32 s38, 86016
  s_cselect_b32 s17, 86016, 0
  s_sub_u32 s38, s38, s17
  s_waitcnt lgkmcnt(5)
  v_mfma_f32_32x32x16_bf16 v[64:79], v[120:123], a[56:59], v[64:79]
  ds_read_b128 v[112:115], v6 offset:20480
  v_mfma_f32_32x32x16_bf16 v[80:95], v[120:123], a[168:171], v[80:95]
  s_waitcnt lgkmcnt(5)
  v_mfma_f32_32x32x16_bf16 v[64:79], v[124:127], a[60:63], v[64:79]
  ds_read_b128 v[116:119], v6 offset:21504
  v_mfma_f32_32x32x16_bf16 v[80:95], v[124:127], a[172:175], v[80:95]
  s_waitcnt lgkmcnt(5)
  v_mfma_f32_32x32x16_bf16 v[64:79], v[96:99], a[64:67], v[64:79]
  ds_read_b128 v[120:123], v6 offset:22528
  v_mfma_f32_32x32x16_bf16 v[80:95], v[96:99], a[176:179], v[80:95]
  s_waitcnt lgkmcnt(5)
  v_mfma_f32_32x32x16_bf16 v[64:79], v[100:103], a[68:71], v[64:79]
  ds_read_b128 v[124:127], v6 offset:23552
  v_mfma_f32_32x32x16_bf16 v[80:95], v[100:103], a[180:183], v[80:95]
  s_waitcnt lgkmcnt(5)
  v_mfma_f32_32x32x16_bf16 v[64:79], v[104:107], a[72:75], v[64:79]
  ds_read_b128 v[96:99], v6 offset:24576
  v_mfma_f32_32x32x16_bf16 v[80:95], v[104:107], a[184:187], v[80:95]
  s_waitcnt lgkmcnt(5)
  v_mfma_f32_32x32x16_bf16 v[64:79], v[108:111], a[76:79], v[64:79]
  ds_read_b128 v[100:103], v6 offset:25600
  v_mfma_f32_32x32x16_bf16 v[80:95], v[108:111], a[188:191], v[80:95]
  s_waitcnt lgkmcnt(5)
  v_mfma_f32_32x32x16_bf16 v[64:79], v[112:115], a[80:83], v[64:79]
  ds_read_b128 v[104:107], v6 offset:26624
  v_mfma_f32_32x32x16_bf16 v[80:95], v[112:115], a[192:195], v[80:95]
  s_waitcnt lgkmcnt(5)
  v_mfma_f32_32x32x16_bf16 v[64:79], v[116:119], a[84:87], v[64:79]
  ds_read_b128 v[108:111], v6 offset:27648
  v_mfma_f32_32x32x16_bf16 v[80:95], v[116:119], a[196:199], v[80:95]
  s_waitcnt lgkmcnt(5)
  v_mfma_f32_32x32x16_bf16 v[64:79], v[120:123], a[88:91], v[64:79]
  v_mfma_f32_32x32x16_bf16 v[80:95], v[120:123], a[200:203], v[80:95]
  s_waitcnt lgkmcnt(4)
  v_mfma_f32_32x32x16_bf16 v[64:79], v[124:127], a[92:95], v[64:79]
  v_mfma_f32_32x32x16_bf16 v[80:95], v[124:127], a[204:207], v[80:95]
  s_waitcnt lgkmcnt(3)
  v_mfma_f32_32x32x16_bf16 v[64:79], v[96:99], a[96:99], v[64:79]
  v_mfma_f32_32x32x16_bf16 v[80:95], v[96:99], a[208:211], v[80:95]
  s_waitcnt lgkmcnt(2)
  v_mfma_f32_32x32x16_bf16 v[64:79], v[100:103], a[100:103], v[64:79]
  v_mfma_f32_32x32x16_bf16 v[80:95], v[100:103], a[212:215], v[80:95]
  s_waitcnt lgkmcnt(1)
  v_mfma_f32_32x32x16_bf16 v[64:79], v[104:107], a[104:107], v[64:79]
  v_mfma_f32_32x32x16_bf16 v[80:95], v[104:107], a[216:219], v[80:95]
  s_waitcnt lgkmcnt(0)
  v_mfma_f32_32x32x16_bf16 v[64:79], v[108:111], a[108:111], v[64:79]
  v_mfma_f32_32x32x16_bf16 v[80:95], v[108:111], a[220:223], v[80:95]
  s_cmp_lt_u32 s36, s35
  s_cbranch_scc1 EU_top
  s_nop 1
  v_cvt_pk_bf16_f32 v128, v64, v65
  v_cvt_pk_bf16_f32 v129, v66, v67
  v_cvt_pk_bf16_f32 v130, v68, v69
  v_cvt_pk_bf16_f32 v131, v70, v71
  buffer_store_dwordx4 v[128:131], v2, s[8:11], s30 offen offset:0 sc1
  v_cvt_pk_bf16_f32 v132, v72, v73
  v_cvt_pk_bf16_f32 v133, v74, v75
  v_cvt_pk_bf16_f32 v134, v76, v77
  v_cvt_pk_bf16_f32 v135, v78, v79
  buffer_store_dwordx4 v[132:135], v2, s[8:11], s30 offen offset:1024 sc1
  v_cvt_pk_bf16_f32 v136, v80, v81
  v_cvt_pk_bf16_f32 v137, v82, v83
  v_cvt_pk_bf16_f32 v138, v84, v85
  v_cvt_pk_bf16_f32 v139, v86, v87
  buffer_store_dwordx4 v[136:139], v2, s[8:11], s31 offen offset:0 sc1
  v_cvt_pk_bf16_f32 v140, v88, v89
  v_cvt_pk_bf16_f32 v141, v90, v91
  v_cvt_pk_bf16_f32 v142, v92, v93
  v_cvt_pk_bf16_f32 v143, v94, v95
  buffer_store_dwordx4 v[140:143], v2, s[8:11], s31 offen offset:1024 sc1
  s_add_u32 s30, s30, s32
  s_add_u32 s31, s31, s32
  v_mov_b32 v144, -1
  v_mov_b32 v145, -1
  v_mov_b32 v146, -1
  v_mov_b32 v147, -1
  s_mul_i32 s17, s41, 112
  s_add_u32 s17, s17, s50
  s_lshl_b32 s17, s17, 10
  s_add_u32 s17, s17, 92717056
  buffer_store_dwordx4 v[144:147], v2, s[8:11], s17 offen sc1
  s_cmp_lt_u32 s50, 32
  s_cselect_b32 s17, 5, 3
  s_cselect_b32 s18, 0, 589824
  s_add_u32 s18, s18, 95141888
  s_lshl_b32 s17, s41, s17
  s_add_u32 s17, s17, s50
  s_lshl_b32 s17, s17, 10
  s_add_u32 s17, s17, s18
  s_cmp_lt_u32 s50, 40
  s_cselect_b32 s17, s17, 0x7f000000
  buffer_store_dwordx4 v[144:147], v2, s[8:11], s17 offen sc1
  s_waitcnt vmcnt(0)
  s_barrier
  buffer_atomic_add v5, v4, s[8:11], s33 offen sc1
  s_add_u32 s33, s33, s34
  buffer_atomic_add v5, v4, s[8:11], s33 offen sc1
  s_cmp_eq_u32 s40, 0
  s_cbranch_scc1 W_next
  s_mov_b32 s30, s40
  s_mul_i32 s38, s13, 7168
  s_add_u32 s28, s38, 1179648
  v_add_u32 v8, s38, v2
  v_mov_b32 v6, v2
  s_mov_b32 s33, 51200
  s_mov_b32 s36, 0
  s_mov_b64 s[52:53], -1
  s_mov_b64 s[54:55], 0
  s_mov_b32 s39, 1207552
EY_top:
  s_add_u32 s17, s28, 4096
EY_l:
  buffer_load_dword v7, v3, s[8:11], s39 offen sc1
  s_sub_u32 s25, s25, 1
  s_cbranch_scc1 abort
  s_sleep 8
  s_waitcnt vmcnt(0)
  v_cmp_eq_u32 vcc, -1, v7
  s_cbranch_vccnz EY_l
  buffer_load_dwordx4 v[144:147], v2, s[8:11], s28 offen offset:0 sc1
  buffer_load_dwordx4 v[148:151], v2, s[8:11], s28 offen offset:1024 sc1
  buffer_load_dwordx4 v[152:155], v2, s[8:11], s28 offen offset:2048 sc1
  buffer_load_dwordx4 v[156:159], v2, s[8:11], s28 offen offset:3072 sc1
  buffer_load_dwordx4 v[160:163], v2, s[8:11], s17 offen offset:0 sc1
  buffer_load_dwordx4 v[164:167], v2, s[8:11], s17 offen offset:1024 sc1
  buffer_load_dwordx4 v[168:171], v2, s[8:11], s17 offen offset:2048 sc1
  s_sleep 12
EY_p:
  buffer_load_dwordx4 v[172:175], v2, s[8:11], s28 offen offset:0 sc1
  buffer_load_dwordx4 v[176:179], v2, s[8:11], s28 offen offset:1024 sc1
  buffer_load_dwordx4 v[180:183], v2, s[8:11], s28 offen offset:2048 sc1
  buffer_load_dwordx4 v[184:187], v2, s[8:11], s28 offen offset:3072 sc1
  buffer_load_dwordx4 v[188:191], v2, s[8:11], s17 offen offset:0 sc1
  buffer_load_dwordx4 v[192:195], v2, s[8:11], s17 offen offset:1024 sc1
  buffer_load_dwordx4 v[196:199], v2, s[8:11], s17 offen offset:2048 sc1
  s_waitcnt vmcnt(7)
  v_max3_u32 v7, v144, v145, v146
  v_max3_u32 v7, v7, v147, v148
  v_max3_u32 v7, v7, v149, v150
  v_max3_u32 v7, v7, v151, v152
  v_max3_u32 v7, v7, v153, v154
  v_max3_u32 v7, v7, v155, v156
  v_max3_u32 v7, v7, v157, v158
  v_max3_u32 v7, v7, v159, v160
  v_max3_u32 v7, v7, v161, v162
  v_max3_u32 v7, v7, v163, v164
  v_max3_u32 v7, v7, v165, v166
  v_max3_u32 v7, v7, v167, v168
  v_max3_u32 v7, v7, v169, v170
  v_max_u32 v7, v7, v171
  v_cmp_eq_u32 vcc, -1, v7
  s_nop 0
  s_and_b64 vcc, vcc, s[52:53]
  s_cbranch_scc0 EY_p_a
  buffer_load_dwordx4 v[144:147], v2, s[8:11], s28 offen offset:0 sc1
  buffer_load_dwordx4 v[148:151], v2, s[8:11], s28 offen offset:1024 sc1
  buffer_load_dwordx4 v[152:155], v2, s[8:11], s28 offen offset:2048 sc1
  buffer_load_dwordx4 v[156:159], v2, s[8:11], s28 offen offset:3072 sc1
  buffer_load_dwordx4 v[160:163], v2, s[8:11], s17 offen offset:0 sc1
  buffer_load_dwordx4 v[164:167], v2, s[8:11], s17 offen offset:1024 sc1
  buffer_load_dwordx4 v[168:171], v2, s[8:11], s17 offen offset:2048 sc1
  s_waitcnt vmcnt(7)
  v_max3_u32 v7, v172, v173, v174
  v_max3_u32 v7, v7, v175, v176
  v_max3_u32 v7, v7, v177, v178
  v_max3_u32 v7, v7, v179, v180
  v_max3_u32 v7, v7, v181, v182
  v_max3_u32 v7, v7, v183, v184
  v_max3_u32 v7, v7, v185, v186
  v_max3_u32 v7, v7, v187, v188
  v_max3_u32 v7, v7, v189, v190
  v_max3_u32 v7, v7, v191, v192
  v_max3_u32 v7, v7, v193, v194
  v_max3_u32 v7, v7, v195, v196
  v_max3_u32 v7, v7, v197, v198
  v_max_u32 v7, v7, v199
  v_cmp_eq_u32 vcc, -1, v7
  s_nop 0
  s_and_b64 vcc, vcc, s[52:53]
  s_cbranch_scc0 EY_p_b
  s_sub_u32 s25, s25, 1
  s_cbranch_scc0 EY_p
  s_branch abort
EY_p_b:
  ds_write_b128 v8, v[172:175] offset:0
  ds_write_b128 v8, v[176:179] offset:1024
  ds_write_b128 v8, v[180:183] offset:2048
  ds_write_b128 v8, v[184:187] offset:3072
  ds_write_b128 v8, v[188:191] offset:4096
  ds_write_b128 v8, v[192:195] offset:5120
  ds_write_b128 v8, v[196:199] offset:6144
  s_branch EY_p_ok
EY_p_a:
  ds_write_b128 v8, v[144:147] offset:0
  ds_write_b128 v8, v[148:151] offset:1024
  ds_write_b128 v8, v[152:155] offset:2048
  ds_write_b128 v8, v[156:159] offset:3072
  ds_write_b128 v8, v[160:163] offset:4096
  ds_write_b128 v8, v[164:167] offset:5120
  ds_write_b128 v8, v[168:171] offset:6144
EY_p_ok:
  s_add_u32 s39, s39, 28672
  s_waitcnt lgkmcnt(0)
  s_barrier
  ds_read_b128 v[96:99], v6 offset:0
  ds_read_b128 v[100:103], v6 offset:1024
  ds_read_b128 v[104:107], v6 offset:2048
  ds_read_b128 v[108:111], v6 offset:3072
  ds_read_b128 v[112:115], v6 offset:4096
  ds_read_b128 v[116:119], v6 offset:5120
  s_waitcnt lgkmcnt(5)
  v_mfma_f32_32x32x16_bf16 v[64:79], v[96:99], a[0:3], 0
  ds_read_b128 v[120:123], v6 offset:6144
  v_mfma_f32_32x32x16_bf16 v[80:95], v[96:99], a[112:115], 0
  s_waitcnt lgkmcnt(5)
  v_mfma_f32_32x32x16_bf16 v[64:79], v[100:103], a[4:7], v[64:79]
  ds_read_b128 v[124:127], v6 offset:7168
  v_mfma_f32_32x32x16_bf16 v[80:95], v[100:103], a[116:119], v[80:95]
  s_waitcnt lgkmcnt(5)
  v_mfma_f32_32x32x16_bf16 v[64:79], v[104:107], a[8:11], v[64:79]
  ds_read_b128 v[96:99], v6 offset:8192
  v_mfma_f32_32x32x16_bf16 v[80:95], v[104:107], a[120:123], v[80:95]
  s_waitcnt lgkmcnt(5)
  v_mfma_f32_32x32x16_bf16 v[64:79], v[108:111], a[12:15], v[64:79]
  ds_read_b128 v[100:103], v6 offset:9216
  v_mfma_f32_32x32x16_bf16 v[80:95], v[108:111], a[124:127], v[80:95]
  s_waitcnt lgkmcnt(5)
  v_mfma_f32_32x32x16_bf16 v[64:79], v[112:115], a[16:19], v[64:79]
  ds_read_b128 v[104:107], v6 offset:10240
  v_mfma_f32_32x32x16_bf16 v[80:95], v[112:115], a[128:131], v[80:95]
  s_waitcnt lgkmcnt(5)
  v_mfma_f32_32x32x16_bf16 v[64:79], v[116:119], a[20:23], v[64:79]
  ds_read_b128 v[108:111], v6 offset:11264
  v_mfma_f32_32x32x16_bf16 v[80:95], v[116:119], a[132:135], v[80:95]
  s_waitcnt lgkmcnt(5)
  v_mfma_f32_32x32x16_bf16 v[64:79], v[120:123], a[24:27], v[64:79]
  ds_read_b128 v[112:115], v6 offset:12288
  v_mfma_f32_32x32x16_bf16 v[80:95], v[120:123], a[136:139], v[80:95]
  s_waitcnt lgkmcnt(5)
  v_mfma_f32_32x32x16_bf16 v[64:79], v[124:127], a[28:31], v[64:79]
  ds_read_b128 v[116:119], v6 offset:13312
  v_mfma_f32_32x32x16_bf16 v[80:95], v[124:127], a[140:143], v[80:95]
  s_waitcnt lgkmcnt(5)
  v_mfma_f32_32x32x16_bf16 v[64:79], v[96:99], a[32:35], v[64:79]
  ds_read_b128 v[120:123], v6 offset:14336
  v_mfma_f32_32x32x16_bf16 v[80:95], v[96:99], a[144:147], v[80:95]
  s_waitcnt lgkmcnt(5)
  v_mfma_f32_32x32x16_bf16 v[64:79], v[100:103], a[36:39], v[64:79]
  ds_read_b128 v[124:127], v6 offset:15360
  v_mfma_f32_32x32x16_bf16 v[80:95], v[100:103], a[148:151], v[80:95]
  s_waitcnt lgkmcnt(5)
  v_mfma_f32_32x32x16_bf16 v[64:79], v[104:107], a[40:43], v[64:79]
  ds_read_b128 v[96:99], v6 offset:16384
  v_mfma_f32_32x32x16_bf16 v[80:95], v[104:107], a[152:155], v[80:95]
  s_waitcnt lgkmcnt(5)
  v_mfma_f32_32x32x16_bf16 v[64:79], v[108:111], a[44:47], v[64:79]
  ds_read_b128 v[100:103], v6 offset:17408
  v_mfma_f32_32x32x16_bf16 v[80:95], v[108:111], a[156:159], v[80:95]
  s_waitcnt lgkmcnt(5)
  v_mfma_f32_32x32x16_bf16 v[64:79], v[112:115], a[48:51], v[64:79]
  ds_read_b128 v[104:107], v6 offset:18432
  v_mfma_f32_32x32x16_bf16 v[80:95], v[112:115], a[160:163], v[80:95]
  s_waitcnt lgkmcnt(5)
  v_mfma_f32_32x32x16_bf16 v[64:79], v[116:119], a[52:55], v[64:79]
  ds_read_b128 v[108:111], v6 offset:19456
  v_mfma_f32_32x32x16_bf16 v[80:95], v[116:119], a[164:167], v[80:95]
  s_waitcnt lgkmcnt(5)
  v_mfma_f32_32x32x16_bf16 v[64:79], v[120:123], a[56:59], v[64:79]
  ds_read_b128 v[112:115], v6 offset:20480
  v_mfma_f32_32x32x16_bf16 v[80:95], v[120:123], a[168:171], v[80:95]
  s_waitcnt lgkmcnt(5)
  v_mfma_f32_32x32x16_bf16 v[64:79], v[124:127], a[60:63], v[64:79]
  ds_read_b128 v[116:119], v6 offset:21504
  v_mfma_f32_32x32x16_bf16 v[80:95], v[124:127], a[172:175], v[80:95]
  s_waitcnt lgkmcnt(5)
  v_mfma_f32_32x32x16_bf16 v[64:79], v[96:99], a[64:67], v[64:79]
  ds_read_b128 v[120:123], v6 offset:22528
  v_mfma_f32_32x32x16_bf16 v[80:95], v[96:99], a[176:179], v[80:95]
  s_waitcnt lgkmcnt(5)
  v_mfma_f32_32x32x16_bf16 v[64:79], v[100:103], a[68:71], v[64:79]
  ds_read_b128 v[124:127], v6 offset:23552
  v_mfma_f32_32x32x16_bf16 v[80:95], v[100:103], a[180:183], v[80:95]
  s_waitcnt lgkmcnt(5)
  v_mfma_f32_32x32x16_bf16 v[64:79], v[104:107], a[72:75], v[64:79]
  ds_read_b128 v[96:99], v6 offset:24576
  v_mfma_f32_32x32x16_bf16 v[80:95], v[104:107], a[184:187], v[80:95]
  s_waitcnt lgkmcnt(5)
  v_mfma_f32_32x32x16_bf16 v[64:79], v[108:111], a[76:79], v[64:79]
  ds_read_b128 v[100:103], v6 offset:25600
  v_mfma_f32_32x32x16_bf16 v[80:95], v[108:111], a[188:191], v[80:95]
  s_waitcnt lgkmcnt(5)
  v_mfma_f32_32x32x16_bf16 v[64:79], v[112:115], a[80:83], v[64:79]
  ds_read_b128 v[104:107], v6 offset:26624
  v_mfma_f32_32x32x16_bf16 v[80:95], v[112:115], a[192:195], v[80:95]
  s_waitcnt lgkmcnt(5)
  v_mfma_f32_32x32x16_bf16 v[64:79], v[116:119], a[84:87], v[64:79]
  ds_read_b128 v[108:111], v6 offset:27648
  v_mfma_f32_32x32x16_bf16 v[80:95], v[116:119], a[196:199], v[80:95]
  s_waitcnt lgkmcnt(5)
  v_mfma_f32_32x32x16_bf16 v[64:79], v[120:123], a[88:91], v[64:79]
  v_mfma_f32_32x32x16_bf16 v[80:95], v[120:123], a[200:203], v[80:95]
  s_waitcnt lgkmcnt(4)
  v_mfma_f32_32x32x16_bf16 v[64:79], v[124:127], a[92:95], v[64:79]
  v_mfma_f32_32x32x16_bf16 v[80:95], v[124:127], a[204:207], v[80:95]
  s_waitcnt lgkmcnt(3)
  v_mfma_f32_32x32x16_bf16 v[64:79], v[96:99], a[96:99], v[64:79]
  v_mfma_f32_32x32x16_bf16 v[80:95], v[96:99], a[208:211], v[80:95]
  s_waitcnt lgkmcnt(2)
  v_mfma_f32_32x32x16_bf16 v[64:79], v[100:103], a[100:103], v[64:79]
  v_mfma_f32_32x32x16_bf16 v[80:95], v[100:103], a[212:215], v[80:95]
  s_waitcnt lgkmcnt(1)
  v_mfma_f32_32x32x16_bf16 v[64:79], v[104:107], a[104:107], v[64:79]
  v_mfma_f32_32x32x16_bf16 v[80:95], v[104:107], a[216:219], v[80:95]
  s_waitcnt lgkmcnt(0)
  v_mfma_f32_32x32x16_bf16 v[64:79], v[108:111], a[108:111], v[64:79]
  v_mfma_f32_32x32x16_bf16 v[80:95], v[108:111], a[220:223], v[80:95]
  s_nop 3
  v_cvt_pk_bf16_f32 v128, v64, v65
  v_min_u32 v128, -2, v128
  v_cvt_pk_bf16_f32 v129, v66, v67
  v_min_u32 v129, -2, v129
  s_nop 3
  v_cvt_pk_bf16_f32 v130, v80, v81
  v_min_u32 v130, -2, v130
  v_cvt_pk_bf16_f32 v131, v82, v83
  v_min_u32 v131, -2, v131
  s_add_u32 s17, s30, s54
  buffer_store_dwordx4 v[128:131], v2, s[8:11], s17 offen sc1
  s_add_u32 s30, s30, 114688
  v_cvt_pk_bf16_f32 v132, v68, v69
  v_min_u32 v132, -2, v132
  v_cvt_pk_bf16_f32 v133, v70, v71
  v_min_u32 v133, -2, v133
  v_cvt_pk_bf16_f32 v134, v84, v85
  v_min_u32 v134, -2, v134
  v_cvt_pk_bf16_f32 v135, v86, v87
  v_min_u32 v135, -2, v135
  s_add_u32 s17, s30, s54
  buffer_store_dwordx4 v[132:135], v2, s[8:11], s17 offen sc1
  s_add_u32 s30, s30, 114688
  v_cvt_pk_bf16_f32 v136, v72, v73
  v_min_u32 v136, -2, v136
  v_cvt_pk_bf16_f32 v137, v74, v75
  v_min_u32 v137, -2, v137
  v_cvt_pk_bf16_f32 v138, v88, v89
  v_min_u32 v138, -2, v138
  v_cvt_pk_bf16_f32 v139, v90, v91
  v_min_u32 v139, -2, v139
  s_add_u32 s17, s30, s54
  buffer_store_dwordx4 v[136:139], v2, s[8:11], s17 offen sc1
  s_add_u32 s30, s30, 114688
  v_cvt_pk_bf16_f32 v140, v76, v77
  v_min_u32 v140, -2, v140
  v_cvt_pk_bf16_f32 v141, v78, v79
  v_min_u32 v141, -2, v141
  v_cvt_pk_bf16_f32 v142, v92, v93
  v_min_u32 v142, -2, v142
  v_cvt_pk_bf16_f32 v143, v94, v95
  v_min_u32 v143, -2, v143
  s_add_u32 s17, s30, s55
  buffer_store_dwordx4 v[140:143], v2, s[8:11], s17 offen sc1
  s_add_u32 s30, s30, 114688
  s_add_u32 s36, s36, 1
  s_cmp_ge_u32 s36, 16
  s_cbranch_scc1 EY_last
  s_waitcnt vmcnt(0)
  s_barrier
  buffer_atomic_add v5, v4, s[8:11], s33 offen sc1
  s_add_u32 s33, s33, 128
  s_add_u32 s28, s28, 28672
  s_cmp_lt_u32 s36, 15
  s_cbranch_scc1 EY_top
  s_mov_b32 s52, 0xffffff
  s_mov_b32 s53, 0xffffff
  s_mov_b32 s55, 0x7f000000
  s_sub_u32 s39, s39, 128
  s_branch EY_top
EY_last:
  s_endpgm
EH:
  s_add_u32 s17, s26, 0
  buffer_load_dwordx4 a[0:3], v2, s[8:11], s17 offen offset:0
  buffer_load_dwordx4 a[4:7], v2, s[8:11], s17 offen offset:1024
  buffer_load_dwordx4 a[8:11], v2, s[8:11], s17 offen offset:2048
  buffer_load_dwordx4 a[12:15], v2, s[8:11], s17 offen offset:3072
  s_add_u32 s17, s26, 4096
  buffer_load_dwordx4 a[16:19], v2, s[8:11], s17 offen offset:0
  buffer_load_dwordx4 a[20:23], v2, s[8:11], s17 offen offset:1024
  buffer_load_dwordx4 a[24:27], v2, s[8:11], s17 offen offset:2048
  buffer_load_dwordx4 a[28:31], v2, s[8:11], s17 offen offset:3072
  s_add_u32 s17, s26, 8192
  buffer_load_dwordx4 a[32:35], v2, s[8:11], s17 offen offset:0
  buffer_load_dwordx4 a[36:39], v2, s[8:11], s17 offen offset:1024
  buffer_load_dwordx4 a[40:43], v2, s[8:11], s17 offen offset:2048
  buffer_load_dwordx4 a[44:47], v2, s[8:11], s17 offen offset:3072
  s_add_u32 s17, s26, 12288
  buffer_load_dwordx4 a[48:51], v2, s[8:11], s17 offen offset:0
  buffer_load_dwordx4 a[52:55], v2, s[8:11], s17 offen offset:1024
  buffer_load_dwordx4 a[56:59], v2, s[8:11], s17 offen offset:2048
  buffer_load_dwordx4 a[60:63], v2, s[8:11], s17 offen offset:3072
  s_add_u32 s17, s26, 16384
  buffer_load_dwordx4 a[64:67], v2, s[8:11], s17 offen offset:0
  buffer_load_dwordx4 a[68:71], v2, s[8:11], s17 offen offset:1024
  buffer_load_dwordx4 a[72:75], v2, s[8:11], s17 offen offset:2048
  buffer_load_dwordx4 a[76:79], v2, s[8:11], s17 offen offset:3072
  s_add_u32 s17, s26, 20480
  buffer_load_dwordx4 a[80:83], v2, s[8:11], s17 offen offset:0
  buffer_load_dwordx4 a[84:87], v2, s[8:11], s17 offen offset:1024
  buffer_load_dwordx4 a[88:91], v2, s[8:11], s17 offen offset:2048
  buffer_load_dwordx4 a[92:95], v2, s[8:11], s17 offen offset:3072
  s_add_u32 s17, s26, 24576
  buffer_load_dwordx4 a[96:99], v2, s[8:11], s17 offen offset:0
  buffer_load_dwordx4 a[100:103], v2, s[8:11], s17 offen offset:1024
  buffer_load_dwordx4 a[104:107], v2, s[8:11], s17 offen offset:2048
  buffer_load_dwordx4 a[108:111], v2, s[8:11], s17 offen offset:3072
  s_add_u32 s17, s27, 0
  buffer_load_dwordx4 a[112:115], v2, s[8:11], s17 offen offset:0
  buffer_load_dwordx4 a[116:119], v2, s[8:11], s17 offen offset:1024
  buffer_load_dwordx4 a[120:123], v2, s[8:11], s17 offen offset:2048
  buffer_load_dwordx4 a[124:127], v2, s[8:11], s17 offen offset:3072
  s_add_u32 s17, s27, 4096
  buffer_load_dwordx4 a[128:131], v2, s[8:11], s17 offen offset:0
  buffer_load_dwordx4 a[132:135], v2, s[8:11], s17 offen offset:1024
  buffer_load_dwordx4 a[136:139], v2, s[8:11], s17 offen offset:2048
  buffer_load_dwordx4 a[140:143], v2, s[8:11], s17 offen offset:3072
  s_add_u32 s17, s27, 8192
  buffer_load_dwordx4 a[144:147], v2, s[8:11], s17 offen offset:0
  buffer_load_dwordx4 a[148:151], v2, s[8:11], s17 offen offset:1024
  buffer_load_dwordx4 a[152:155], v2, s[8:11], s17 offen offset:2048
  buffer_load_dwordx4 a[156:159], v2, s[8:11], s17 offen offset:3072
  s_add_u32 s17, s27, 12288
  buffer_load_dwordx4 a[160:163], v2, s[8:11], s17 offen offset:0
  buffer_load_dwordx4 a[164:167], v2, s[8:11], s17 offen offset:1024
  buffer_load_dwordx4 a[168:171], v2, s[8:11], s17 offen offset:2048
  buffer_load_dwordx4 a[172:175], v2, s[8:11], s17 offen offset:3072
  s_add_u32 s17, s27, 16384
  buffer_load_dwordx4 a[176:179], v2, s[8:11], s17 offen offset:0
  buffer_load_dwordx4 a[180:183], v2, s[8:11], s17 offen offset:1024
  buffer_load_dwordx4 a[184:187], v2, s[8:11], s17 offen offset:2048
  buffer_load_dwordx4 a[188:191], v2, s[8:11], s17 offen offset:3072
  s_add_u32 s17, s27, 20480
  buffer_load_dwordx4 a[192:195], v2, s[8:11], s17 offen offset:0
  buffer_load_dwordx4 a[196:199], v2, s[8:11], s17 offen offset:1024
  buffer_load_dwordx4 a[200:203], v2, s[8:11], s17 offen offset:2048
  buffer_load_dwordx4 a[204:207], v2, s[8:11], s17 offen offset:3072
  s_add_u32 s17, s27, 24576
  buffer_load_dwordx4 a[208:211], v2, s[8:11], s17 offen offset:0
  buffer_load_dwordx4 a[212:215], v2, s[8:11], s17 offen offset:1024
  buffer_load_dwordx4 a[216:219], v2, s[8:11], s17 offen offset:2048
  buffer_load_dwordx4 a[220:223], v2, s[8:11], s17 offen offset:3072
  s_mul_i32 s38, s13, 7168
  s_add_u32 s28, s28, s38
  s_mov_b32 s37, 0
  s_mov_b32 s36, 0
  s_waitcnt vmcnt(40)
  s_mov_b32 m0, s38
  s_nop 0
  buffer_load_dwordx4 v2, s[8:11], s28 offen offset:0 sc1 lds
  buffer_load_dwordx4 v2, s[8:11], s28 offen offset:1024 sc1 lds
  buffer_load_dwordx4 v2, s[8:11], s28 offen offset:2048 sc1 lds
  buffer_load_dwordx4 v2, s[8:11], s28 offen offset:3072 sc1 lds
  s_add_u32 m0, s38, 4096
  s_add_u32 s17, s28, 4096
  buffer_load_dwordx4 v2, s[8:11], s17 offen offset:0 sc1 lds
  buffer_load_dwordx4 v2, s[8:11], s17 offen offset:1024 sc1 lds
  buffer_load_dwordx4 v2, s[8:11], s17 offen offset:2048 sc1 lds
  s_add_u32 s28, s28, s29
  s_add_u32 s38, s38, 28672
  s_cmp_ge_u32 s38, 86016
  s_cselect_b32 s17, 86016, 0
  s_sub_u32 s38, s38, s17
  s_mov_b32 m0, s38
  s_nop 0
  buffer_load_dwordx4 v2, s[8:11], s28 offen offset:0 sc1 lds
  buffer_load_dwordx4 v2, s[8:11], s28 offen offset:1024 sc1 lds
  buffer_load_dwordx4 v2, s[8:11], s28 offen offset:2048 sc1 lds
  buffer_load_dwordx4 v2, s[8:11], s28 offen offset:3072 sc1 lds
  s_add_u32 m0, s38, 4096
  s_add_u32 s17, s28, 4096
  buffer_load_dwordx4 v2, s[8:11], s17 offen offset:0 sc1 lds
  buffer_load_dwordx4 v2, s[8:11], s17 offen offset:1024 sc1 lds
  buffer_load_dwordx4 v2, s[8:11], s17 offen offset:2048 sc1 lds
  s_add_u32 s28, s28, s29
  s_add_u32 s38, s38, 28672
  s_cmp_ge_u32 s38, 86016
  s_cselect_b32 s17, 86016, 0
  s_sub_u32 s38, s38, s17
EH_top:
  v_add_u32 v6, s37, v2
  s_waitcnt vmcnt(7)
  s_barrier
  ds_read_b128 v[96:99], v6 offset:0
  ds_read_b128 v[100:103], v6 offset:1024
  ds_read_b128 v[104:107], v6 offset:2048
  ds_read_b128 v[108:111], v6 offset:3072
  ds_read_b128 v[112:115], v6 offset:4096
  ds_read_b128 v[116:119], v6 offset:5120
  s_add_u32 s37, s37, 28672
  s_cmp_ge_u32 s37, 86016
  s_cselect_b32 s37, 0, s37
  s_cmp_lt_u32 s36, 2
  s_cbranch_scc1 EH_nosig
  buffer_atomic_add v5, v4, s[8:11], s33 offen sc1
  s_add_u32 s33, s33, s34
EH_nosig:
  s_cmp_lt_u32 s36, 1
  s_cbranch_scc1 EH_noepi
  v_cvt_pk_bf16_f32 v128, v64, v65
  v_pk_max_i16 v128, v128, 0
  v_cvt_pk_bf16_f32 v129, v66, v67
  v_pk_max_i16 v129, v129, 0
  v_cvt_pk_bf16_f32 v130, v68, v69
  v_pk_max_i16 v130, v130, 0
  v_cvt_pk_bf16_f32 v131, v70, v71
  v_pk_max_i16 v131, v131, 0
  buffer_store_dwordx4 v[128:131], v2, s[8:11], s30 offen offset:0 sc1
  v_cvt_pk_bf16_f32 v132, v72, v73
  v_pk_max_i16 v132, v132, 0
  v_cvt_pk_bf16_f32 v133, v74, v75
  v_pk_max_i16 v133, v133, 0
  v_cvt_pk_bf16_f32 v134, v76, v77
  v_pk_max_i16 v134, v134, 0
  v_cvt_pk_bf16_f32 v135, v78, v79
  v_pk_max_i16 v135, v135, 0
  buffer_store_dwordx4 v[132:135], v2, s[8:11], s30 offen offset:1024 sc1
  v_cvt_pk_bf16_f32 v136, v80, v81
  v_pk_max_i16 v136, v136, 0
  v_cvt_pk_bf16_f32 v137, v82, v83
  v_pk_max_i16 v137, v137, 0
  v_cvt_pk_bf16_f32 v138, v84, v85
  v_pk_max_i16 v138, v138, 0
  v_cvt_pk_bf16_f32 v139, v86, v87
  v_pk_max_i16 v139, v139, 0
  buffer_store_dwordx4 v[136:139], v2, s[8:11], s31 offen offset:0 sc1
  v_cvt_pk_bf16_f32 v140, v88, v89
  v_pk_max_i16 v140, v140, 0
  v_cvt_pk_bf16_f32 v141, v90, v91
  v_pk_max_i16 v141, v141, 0
  v_cvt_pk_bf16_f32 v142, v92, v93
  v_pk_max_i16 v142, v142, 0
  v_cvt_pk_bf16_f32 v143, v94, v95
  v_pk_max_i16 v143, v143, 0
  buffer_store_dwordx4 v[140:143], v2, s[8:11], s31 offen offset:1024 sc1
  s_add_u32 s30, s30, s32
  s_add_u32 s31, s31, s32
EH_noepi:
  s_add_u32 s36, s36, 1
  s_waitcnt lgkmcnt(5)
  v_mfma_f32_32x32x16_bf16 v[64:79], a[0:3], v[96:99], 0
  ds_read_b128 v[120:123], v6 offset:6144
  v_mfma_f32_32x32x16_bf16 v[80:95], a[112:115], v[96:99], 0
  s_waitcnt lgkmcnt(5)
  v_mfma_f32_32x32x16_bf16 v[64:79], a[4:7], v[100:103], v[64:79]
  ds_read_b128 v[124:127], v6 offset:7168
  v_mfma_f32_32x32x16_bf16 v[80:95], a[116:119], v[100:103], v[80:95]
  s_mov_b32 m0, s38
  s_nop 0
  buffer_load_dwordx4 v2, s[8:11], s28 offen offset:0 sc1 lds
  s_waitcnt lgkmcnt(5)
  v_mfma_f32_32x32x16_bf16 v[64:79], a[8:11], v[104:107], v[64:79]
  ds_read_b128 v[96:99], v6 offset:8192
  v_mfma_f32_32x32x16_bf16 v[80:95], a[120:123], v[104:107], v[80:95]
  s_waitcnt lgkmcnt(5)
  v_mfma_f32_32x32x16_bf16 v[64:79], a[12:15], v[108:111], v[64:79]
  ds_read_b128 v[100:103], v6 offset:9216
  v_mfma_f32_32x32x16_bf16 v[80:95], a[124:127], v[108:111], v[80:95]
  buffer_load_dwordx4 v2, s[8:11], s28 offen offset:1024 sc1 lds
  s_waitcnt lgkmcnt(5)
  v_mfma_f32_32x32x16_bf16 v[64:79], a[16:19], v[112:115], v[64:79]
  ds_read_b128 v[104:107], v6 offset:10240
  v_mfma_f32_32x32x16_bf16 v[80:95], a[128:131], v[112:115], v[80:95]
  s_waitcnt lgkmcnt(5)
  v_mfma_f32_32x32x16_bf16 v[64:79], a[20:23], v[116:119], v[64:79]
  ds_read_b128 v[108:111], v6 offset:11264
  v_mfma_f32_32x32x16_bf16 v[80:95], a[132:135], v[116:119], v[80:95]
  buffer_load_dwordx4 v2, s[8:11], s28 offen offset:2048 sc1 lds
  s_waitcnt lgkmcnt(5)
  v_mfma_f32_32x32x16_bf16 v[64:79], a[24:27], v[120:123], v[64:79]
  ds_read_b128 v[112:115], v6 offset:12288
  v_mfma_f32_32x32x16_bf16 v[80:95], a[136:139], v[120:123], v[80:95]
  s_waitcnt lgkmcnt(5)
  v_mfma_f32_32x32x16_bf16 v[64:79], a[28:31], v[124:127], v[64:79]
  ds_read_b128 v[116:119], v6 offset:13312
  v_mfma_f32_32x32x16_bf16 v[80:95], a[140:143], v[124:127], v[80:95]
  buffer_load_dwordx4 v2, s[8:11], s28 offen offset:3072 sc1 lds
  s_waitcnt lgkmcnt(5)
  v_mfma_f32_32x32x16_bf16 v[64:79], a[32:35], v[96:99], v[64:79]
  ds_read_b128 v[120:123], v6 offset:14336
  v_mfma_f32_32x32x16_bf16 v[80:95], a[144:147], v[96:99], v[80:95]
  s_waitcnt lgkmcnt(5)
  v_mfma_f32_32x32x16_bf16 v[64:79], a[36:39], v[100:103], v[64:79]
  ds_read_b128 v[124:127], v6 offset:15360
  v_mfma_f32_32x32x16_bf16 v[80:95], a[148:151], v[100:103], v[80:95]
  s_add_u32 m0, s38, 4096
  s_add_u32 s17, s28, 4096
  buffer_load_dwordx4 v2, s[8:11], s17 offen offset:0 sc1 lds
  s_waitcnt lgkmcnt(5)
  v_mfma_f32_32x32x16_bf16 v[64:79], a[40:43], v[104:107], v[64:79]
  ds_read_b128 v[96:99], v6 offset:16384
  v_mfma_f32_32x32x16_bf16 v[80:95], a[152:155], v[104:107], v[80:95]
  s_waitcnt lgkmcnt(5)
  v_mfma_f32_32x32x16_bf16 v[64:79], a[44:47], v[108:111], v[64:79]
  ds_read_b128 v[100:103], v6 offset:17408
  v_mfma_f32_32x32x16_bf16 v[80:95], a[156:159], v[108:111], v[80:95]
  buffer_load_dwordx4 v2, s[8:11], s17 offen offset:1024 sc1 lds
  s_waitcnt lgkmcnt(5)
  v_mfma_f32_32x32x16_bf16 v[64:79], a[48:51], v[112:115], v[64:79]
  ds_read_b128 v[104:107], v6 offset:18432
  v_mfma_f32_32x32x16_bf16 v[80:95], a[160:163], v[112:115], v[80:95]
  s_waitcnt lgkmcnt(5)
  v_mfma_f32_32x32x16_bf16 v[64:79], a[52:55], v[116:119], v[64:79]
  ds_read_b128 v[108:111], v6 offset:19456
  v_mfma_f32_32x32x16_bf16 v[80:95], a[164:167], v[116:119], v[80:95]
  buffer_load_dwordx4 v2, s[8:11], s17 offen offset:2048 sc1 lds
  s_add_u32 s28, s28, s29
  s_add_u32 s38, s38, 28672
  s_cmp_ge_u32 s38, 86016
  s_cselect_b32 s17, 86016, 0
  s_sub_u32 s38, s38, s17
  s_waitcnt lgkmcnt(5)
  v_mfma_f32_32x32x16_bf16 v[64:79], a[56:59], v[120:123], v[64:79]
  ds_read_b128 v[112:115], v6 offset:20480
  v_mfma_f32_32x32x16_bf16 v[80:95], a[168:171], v[120:123], v[80:95]
  s_waitcnt lgkmcnt(5)
  v_mfma_f32_32x32x16_bf16 v[64:79], a[60:63], v[124:127], v[64:79]
  ds_read_b128 v[116:119], v6 offset:21504
  v_mfma_f32_32x32x16_bf16 v[80:95], a[172:175], v[124:127], v[80:95]
  s_waitcnt lgkmcnt(5)
  v_mfma_f32_32x32x16_bf16 v[64:79], a[64:67], v[96:99], v[64:79]
  ds_read_b128 v[120:123], v6 offset:22528
  v_mfma_f32_32x32x16_bf16 v[80:95], a[176:179], v[96:99], v[80:95]
  s_waitcnt lgkmcnt(5)
  v_mfma_f32_32x32x16_bf16 v[64:79], a[68:71], v[100:103], v[64:79]
  ds_read_b128 v[124:127], v6 offset:23552
  v_mfma_f32_32x32x16_bf16 v[80:95], a[180:183], v[100:103], v[80:95]
  s_waitcnt lgkmcnt(5)
  v_mfma_f32_32x32x16_bf16 v[64:79], a[72:75], v[104:107], v[64:79]
  ds_read_b128 v[96:99], v6 offset:24576
  v_mfma_f32_32x32x16_bf16 v[80:95], a[184:187], v[104:107], v[80:95]
  s_waitcnt lgkmcnt(5)
  v_mfma_f32_32x32x16_bf16 v[64:79], a[76:79], v[108:111], v[64:79]
  ds_read_b128 v[100:103], v6 offset:25600
  v_mfma_f32_32x32x16_bf16 v[80:95], a[188:191], v[108:111], v[80:95]
  s_waitcnt lgkmcnt(5)
  v_mfma_f32_32x32x16_bf16 v[64:79], a[80:83], v[112:115], v[64:79]
  ds_read_b128 v[104:107], v6 offset:26624
  v_mfma_f32_32x32x16_bf16 v[80:95], a[192:195], v[112:115], v[80:95]
  s_waitcnt lgkmcnt(5)
  v_mfma_f32_32x32x16_bf16 v[64:79], a[84:87], v[116:119], v[64:79]
  ds_read_b128 v[108:111], v6 offset:27648
  v_mfma_f32_32x32x16_bf16 v[80:95], a[196:199], v[116:119], v[80:95]
  s_waitcnt lgkmcnt(5)
  v_mfma_f32_32x32x16_bf16 v[64:79], a[88:91], v[120:123], v[64:79]
  v_mfma_f32_32x32x16_bf16 v[80:95], a[200:203], v[120:123], v[80:95]
  s_waitcnt lgkmcnt(4)
  v_mfma_f32_32x32x16_bf16 v[64:79], a[92:95], v[124:127], v[64:79]
  v_mfma_f32_32x32x16_bf16 v[80:95], a[204:207], v[124:127], v[80:95]
  s_waitcnt lgkmcnt(3)
  v_mfma_f32_32x32x16_bf16 v[64:79], a[96:99], v[96:99], v[64:79]
  v_mfma_f32_32x32x16_bf16 v[80:95], a[208:211], v[96:99], v[80:95]
  s_waitcnt lgkmcnt(2)
  v_mfma_f32_32x32x16_bf16 v[64:79], a[100:103], v[100:103], v[64:79]
  v_mfma_f32_32x32x16_bf16 v[80:95], a[212:215], v[100:103], v[80:95]
  s_waitcnt lgkmcnt(1)
  v_mfma_f32_32x32x16_bf16 v[64:79], a[104:107], v[104:107], v[64:79]
  v_mfma_f32_32x32x16_bf16 v[80:95], a[216:219], v[104:107], v[80:95]
  s_waitcnt lgkmcnt(0)
  v_mfma_f32_32x32x16_bf16 v[64:79], a[108:111], v[108:111], v[64:79]
  v_mfma_f32_32x32x16_bf16 v[80:95], a[220:223], v[108:111], v[80:95]
  s_cmp_lt_u32 s36, s35
  s_cbranch_scc1 EH_top
  s_nop 1
  v_cvt_pk_bf16_f32 v128, v64, v65
  v_pk_max_i16 v128, v128, 0
  v_cvt_pk_bf16_f32 v129, v66, v67
  v_pk_max_i16 v129, v129, 0
  v_cvt_pk_bf16_f32 v130, v68, v69
  v_pk_max_i16 v130, v130, 0
  v_cvt_pk_bf16_f32 v131, v70, v71
  v_pk_max_i16 v131, v131, 0
  buffer_store_dwordx4 v[128:131], v2, s[8:11], s30 offen offset:0 sc1
  v_cvt_pk_bf16_f32 v132, v72, v73
  v_pk_max_i16 v132, v132, 0
  v_cvt_pk_bf16_f32 v133, v74, v75
  v_pk_max_i16 v133, v133, 0
  v_cvt_pk_bf16_f32 v134, v76, v77
  v_pk_max_i16 v134, v134, 0
  v_cvt_pk_bf16_f32 v135, v78, v79
  v_pk_max_i16 v135, v135, 0
  buffer_store_dwordx4 v[132:135], v2, s[8:11], s30 offen offset:1024 sc1
  v_cvt_pk_bf16_f32 v136, v80, v81
  v_pk_max_i16 v136, v136, 0
  v_cvt_pk_bf16_f32 v137, v82, v83
  v_pk_max_i16 v137, v137, 0
  v_cvt_pk_bf16_f32 v138, v84, v85
  v_pk_max_i16 v138, v138, 0
  v_cvt_pk_bf16_f32 v139, v86, v87
  v_pk_max_i16 v139, v139, 0
  buffer_store_dwordx4 v[136:139], v2, s[8:11], s31 offen offset:0 sc1
  v_cvt_pk_bf16_f32 v140, v88, v89
  v_pk_max_i16 v140, v140, 0
  v_cvt_pk_bf16_f32 v141, v90, v91
  v_pk_max_i16 v141, v141, 0
  v_cvt_pk_bf16_f32 v142, v92, v93
  v_pk_max_i16 v142, v142, 0
  v_cvt_pk_bf16_f32 v143, v94, v95
  v_pk_max_i16 v143, v143, 0
  buffer_store_dwordx4 v[140:143], v2, s[8:11], s31 offen offset:1024 sc1
  s_add_u32 s30, s30, s32
  s_add_u32 s31, s31, s32
  s_waitcnt vmcnt(0)
  s_barrier
  buffer_atomic_add v5, v4, s[8:11], s33 offen sc1
  s_add_u32 s33, s33, s34
  buffer_atomic_add v5, v4, s[8:11], s33 offen sc1
  s_branch W_next
EF:
  s_add_u32 s17, s26, 0
  buffer_load_dwordx4 a[0:3], v2, s[8:11], s17 offen offset:0
  buffer_load_dwordx4 a[4:7], v2, s[8:11], s17 offen offset:1024
  buffer_load_dwordx4 a[8:11], v2, s[8:11], s17 offen offset:2048
  buffer_load_dwordx4 a[12:15], v2, s[8:11], s17 offen offset:3072
  s_add_u32 s17, s26, 4096
  buffer_load_dwordx4 a[16:19], v2, s[8:11], s17 offen offset:0
  buffer_load_dwordx4 a[20:23], v2, s[8:11], s17 offen offset:1024
  buffer_load_dwordx4 a[24:27], v2, s[8:11], s17 offen offset:2048
  buffer_load_dwordx4 a[28:31], v2, s[8:11], s17 offen offset:3072
  s_add_u32 s17, s26, 8192
  buffer_load_dwordx4 a[32:35], v2, s[8:11], s17 offen offset:0
  buffer_load_dwordx4 a[36:39], v2, s[8:11], s17 offen offset:1024
  buffer_load_dwordx4 a[40:43], v2, s[8:11], s17 offen offset:2048
  buffer_load_dwordx4 a[44:47], v2, s[8:11], s17 offen offset:3072
  s_add_u32 s17, s26, 12288
  buffer_load_dwordx4 a[48:51], v2, s[8:11], s17 offen offset:0
  buffer_load_dwordx4 a[52:55], v2, s[8:11], s17 offen offset:1024
  buffer_load_dwordx4 a[56:59], v2, s[8:11], s17 offen offset:2048
  buffer_load_dwordx4 a[60:63], v2, s[8:11], s17 offen offset:3072
  s_add_u32 s17, s26, 16384
  buffer_load_dwordx4 a[64:67], v2, s[8:11], s17 offen offset:0
  buffer_load_dwordx4 a[68:71], v2, s[8:11], s17 offen offset:1024
  buffer_load_dwordx4 a[72:75], v2, s[8:11], s17 offen offset:2048
  buffer_load_dwordx4 a[76:79], v2, s[8:11], s17 offen offset:3072
  s_add_u32 s17, s26, 20480
  buffer_load_dwordx4 a[80:83], v2, s[8:11], s17 offen offset:0
  buffer_load_dwordx4 a[84:87], v2, s[8:11], s17 offen offset:1024
  buffer_load_dwordx4 a[88:91], v2, s[8:11], s17 offen offset:2048
  buffer_load_dwordx4 a[92:95], v2, s[8:11], s17 offen offset:3072
  s_add_u32 s17, s26, 24576
  buffer_load_dwordx4 a[96:99], v2, s[8:11], s17 offen offset:0
  buffer_load_dwordx4 a[100:103], v2, s[8:11], s17 offen offset:1024
  buffer_load_dwordx4 a[104:107], v2, s[8:11], s17 offen offset:2048
  buffer_load_dwordx4 a[108:111], v2, s[8:11], s17 offen offset:3072
  s_add_u32 s17, s27, 0
  buffer_load_dwordx4 a[112:115], v2, s[8:11], s17 offen offset:0
  buffer_load_dwordx4 a[116:119], v2, s[8:11], s17 offen offset:1024
  buffer_load_dwordx4 a[120:123], v2, s[8:11], s17 offen offset:2048
  buffer_load_dwordx4 a[124:127], v2, s[8:11], s17 offen offset:3072
  s_add_u32 s17, s27, 4096
  buffer_load_dwordx4 a[128:131], v2, s[8:11], s17 offen offset:0
  buffer_load_dwordx4 a[132:135], v2, s[8:11], s17 offen offset:1024
  buffer_load_dwordx4 a[136:139], v2, s[8:11], s17 offen offset:2048
  buffer_load_dwordx4 a[140:143], v2, s[8:11], s17 offen offset:3072
  s_add_u32 s17, s27, 8192
  buffer_load_dwordx4 a[144:147], v2, s[8:11], s17 offen offset:0
  buffer_load_dwordx4 a[148:151], v2, s[8:11], s17 offen offset:1024
  buffer_load_dwordx4 a[152:155], v2, s[8:11], s17 offen offset:2048
  buffer_load_dwordx4 a[156:159], v2, s[8:11], s17 offen offset:3072
  s_add_u32 s17, s27, 12288
  buffer_load_dwordx4 a[160:163], v2, s[8:11], s17 offen offset:0
  buffer_load_dwordx4 a[164:167], v2, s[8:11], s17 offen offset:1024
  buffer_load_dwordx4 a[168:171], v2, s[8:11], s17 offen offset:2048
  buffer_load_dwordx4 a[172:175], v2, s[8:11], s17 offen offset:3072
  s_add_u32 s17, s27, 16384
  buffer_load_dwordx4 a[176:179], v2, s[8:11], s17 offen offset:0
  buffer_load_dwordx4 a[180:183], v2, s[8:11], s17 offen offset:1024
  buffer_load_dwordx4 a[184:187], v2, s[8:11], s17 offen offset:2048
  buffer_load_dwordx4 a[188:191], v2, s[8:11], s17 offen offset:3072
  s_add_u32 s17, s27, 20480
  buffer_load_dwordx4 a[192:195], v2, s[8:11], s17 offen offset:0
  buffer_load_dwordx4 a[196:199], v2, s[8:11], s17 offen offset:1024
  buffer_load_dwordx4 a[200:203], v2, s[8:11], s17 offen offset:2048
  buffer_load_dwordx4 a[204:207], v2, s[8:11], s17 offen offset:3072
  s_add_u32 s17, s27, 24576
  buffer_load_dwordx4 a[208:211], v2, s[8:11], s17 offen offset:0
  buffer_load_dwordx4 a[212:215], v2, s[8:11], s17 offen offset:1024
  buffer_load_dwordx4 a[216:219], v2, s[8:11], s17 offen offset:2048
  buffer_load_dwordx4 a[220:223], v2, s[8:11], s17 offen offset:3072
  s_mul_i32 s38, s13, 7168
  s_add_u32 s28, s28, s38
  s_mov_b32 s37, 0
  s_mov_b32 s36, 0
  s_waitcnt vmcnt(40)
EF_d0:
  buffer_load_dword v7, v3, s[8:11], s39 offen sc1
  s_waitcnt vmcnt(0)
  v_readfirstlane_b32 s20, v7
  s_nop 0
  s_cmp_ge_u32 s20, 7
  s_cbranch_scc1 EF_d0_ok
  s_sub_u32 s25, s25, 1
  s_cbranch_scc1 abort
  s_sleep 4
  s_branch EF_d0
EF_d0_ok:
  s_add_u32 s39, s39, s34
  s_mov_b32 m0, s38
  s_nop 0
  buffer_load_dwordx4 v2, s[8:11], s28 offen offset:0 sc1 lds
  buffer_load_dwordx4 v2, s[8:11], s28 offen offset:1024 sc1 lds
  buffer_load_dwordx4 v2, s[8:11], s28 offen offset:2048 sc1 lds
  buffer_load_dwordx4 v2, s[8:11], s28 offen offset:3072 sc1 lds
  s_add_u32 m0, s38, 4096
  s_add_u32 s17, s28, 4096
  buffer_load_dwordx4 v2, s[8:11], s17 offen offset:0 sc1 lds
  buffer_load_dwordx4 v2, s[8:11], s17 offen offset:1024 sc1 lds
  buffer_load_dwordx4 v2, s[8:11], s17 offen offset:2048 sc1 lds
  s_add_u32 s28, s28, s29
  s_add_u32 s38, s38, 28672
  s_cmp_ge_u32 s38, 86016
  s_cselect_b32 s17, 86016, 0
  s_sub_u32 s38, s38, s17
EF_d1:
  buffer_load_dword v7, v3, s[8:11], s39 offen sc1
  s_waitcnt vmcnt(0)
  v_readfirstlane_b32 s20, v7
  s_nop 0
  s_cmp_ge_u32 s20, 7
  s_cbranch_scc1 EF_d1_ok
  s_sub_u32 s25, s25, 1
  s_cbranch_scc1 abort
  s_sleep 4
  s_branch EF_d1
EF_d1_ok:
  s_add_u32 s39, s39, s34
  s_mov_b32 m0, s38
  s_nop 0
  buffer_load_dwordx4 v2, s[8:11], s28 offen offset:0 sc1 lds
  buffer_load_dwordx4 v2, s[8:11], s28 offen offset:1024 sc1 lds
  buffer_load_dwordx4 v2, s[8:11], s28 offen offset:2048 sc1 lds
  buffer_load_dwordx4 v2, s[8:11], s28 offen offset:3072 sc1 lds
  s_add_u32 m0, s38, 4096
  s_add_u32 s17, s28, 4096
  buffer_load_dwordx4 v2, s[8:11], s17 offen offset:0 sc1 lds
  buffer_load_dwordx4 v2, s[8:11], s17 offen offset:1024 sc1 lds
  buffer_load_dwordx4 v2, s[8:11], s17 offen offset:2048 sc1 lds
  s_add_u32 s28, s28, s29
  s_add_u32 s38, s38, 28672
  s_cmp_ge_u32 s38, 86016
  s_cselect_b32 s17, 86016, 0
  s_sub_u32 s38, s38, s17
EF_top:
  v_add_u32 v6, s37, v2
  s_waitcnt vmcnt(7)
  s_barrier
  ds_read_b128 v[96:99], v6 offset:0
  ds_read_b128 v[100:103], v6 offset:1024
  ds_read_b128 v[104:107], v6 offset:2048
  ds_read_b128 v[108:111], v6 offset:3072
  ds_read_b128 v[112:115], v6 offset:4096
  ds_read_b128 v[116:119], v6 offset:5120
  s_add_u32 s37, s37, 28672
  s_cmp_ge_u32 s37, 86016
  s_cselect_b32 s37, 0, s37
  s_cmp_lt_u32 s36, 2
  s_cbranch_scc1 EF_nosig
  buffer_atomic_add v5, v4, s[8:11], s33 offen sc1
  s_add_u32 s33, s33, s34
EF_nosig:
  s_cmp_lt_u32 s36, 1
  s_cbranch_scc1 EF_noepi
  buffer_store_dwordx4 v[64:67], v2, s[8:11], s30 offen offset:0 sc1
  buffer_store_dwordx4 v[68:71], v2, s[8:11], s30 offen offset:1024 sc1
  buffer_store_dwordx4 v[72:75], v2, s[8:11], s30 offen offset:2048 sc1
  buffer_store_dwordx4 v[76:79], v2, s[8:11], s30 offen offset:3072 sc1
  buffer_store_dwordx4 v[80:83], v2, s[8:11], s31 offen offset:0 sc1
  buffer_store_dwordx4 v[84:87], v2, s[8:11], s31 offen offset:1024 sc1
  buffer_store_dwordx4 v[88:91], v2, s[8:11], s31 offen offset:2048 sc1
  buffer_store_dwordx4 v[92:95], v2, s[8:11], s31 offen offset:3072 sc1
  s_add_u32 s30, s30, s32
  s_add_u32 s31, s31, s32
EF_noepi:
  s_add_u32 s36, s36, 1
  s_add_u32 s17, s36, 1
  s_cmp_ge_u32 s17, s35
  s_cbranch_scc1 EF_d2_ok
EF_d2:
  buffer_load_dword v7, v3, s[8:11], s39 offen sc1
  s_waitcnt vmcnt(0)
  v_readfirstlane_b32 s20, v7
  s_nop 0
  s_cmp_ge_u32 s20, 7
  s_cbranch_scc1 EF_d2_ok
  s_sub_u32 s25, s25, 1
  s_cbranch_scc1 abort
  s_sleep 4
  s_branch EF_d2
EF_d2_ok:
  s_add_u32 s39, s39, s34
  s_waitcnt lgkmcnt(5)
  v_mfma_f32_32x32x16_bf16 v[64:79], a[0:3], v[96:99], 0
  ds_read_b128 v[120:123], v6 offset:6144
  v_mfma_f32_32x32x16_bf16 v[80:95], a[112:115], v[96:99], 0
  s_waitcnt lgkmcnt(5)
  v_mfma_f32_32x32x16_bf16 v[64:79], a[4:7], v[100:103], v[64:79]
  ds_read_b128 v[124:127], v6 offset:7168
  v_mfma_f32_32x32x16_bf16 v[80:95], a[116:119], v[100:103], v[80:95]
  s_mov_b32 m0, s38
  s_nop 0
  buffer_load_dwordx4 v2, s[8:11], s28 offen offset:0 sc1 lds
  s_waitcnt lgkmcnt(5)
  v_mfma_f32_32x32x16_bf16 v[64:79], a[8:11], v[104:107], v[64:79]
  ds_read_b128 v[96:99], v6 offset:8192
  v_mfma_f32_32x32x16_bf16 v[80:95], a[120:123], v[104:107], v[80:95]
  s_waitcnt lgkmcnt(5)
  v_mfma_f32_32x32x16_bf16 v[64:79], a[12:15], v[108:111], v[64:79]
  ds_read_b128 v[100:103], v6 offset:9216
  v_mfma_f32_32x32x16_bf16 v[80:95], a[124:127], v[108:111], v[80:95]
  buffer_load_dwordx4 v2, s[8:11], s28 offen offset:1024 sc1 lds
  s_waitcnt lgkmcnt(5)
  v_mfma_f32_32x32x16_bf16 v[64:79], a[16:19], v[112:115], v[64:79]
  ds_read_b128 v[104:107], v6 offset:10240
  v_mfma_f32_32x32x16_bf16 v[80:95], a[128:131], v[112:115], v[80:95]
  s_waitcnt lgkmcnt(5)
  v_mfma_f32_32x32x16_bf16 v[64:79], a[20:23], v[116:119], v[64:79]
  ds_read_b128 v[108:111], v6 offset:11264
  v_mfma_f32_32x32x16_bf16 v[80:95], a[132:135], v[116:119], v[80:95]
  buffer_load_dwordx4 v2, s[8:11], s28 offen offset:2048 sc1 lds
  s_waitcnt lgkmcnt(5)
  v_mfma_f32_32x32x16_bf16 v[64:79], a[24:27], v[120:123], v[64:79]
  ds_read_b128 v[112:115], v6 offset:12288
  v_mfma_f32_32x32x16_bf16 v[80:95], a[136:139], v[120:123], v[80:95]
  s_waitcnt lgkmcnt(5)
  v_mfma_f32_32x32x16_bf16 v[64:79], a[28:31], v[124:127], v[64:79]
  ds_read_b128 v[116:119], v6 offset:13312
  v_mfma_f32_32x32x16_bf16 v[80:95], a[140:143], v[124:127], v[80:95]
  buffer_load_dwordx4 v2, s[8:11], s28 offen offset:3072 sc1 lds
  s_waitcnt lgkmcnt(5)
  v_mfma_f32_32x32x16_bf16 v[64:79], a[32:35], v[96:99], v[64:79]
  ds_read_b128 v[120:123], v6 offset:14336
  v_mfma_f32_32x32x16_bf16 v[80:95], a[144:147], v[96:99], v[80:95]
  s_waitcnt lgkmcnt(5)
  v_mfma_f32_32x32x16_bf16 v[64:79], a[36:39], v[100:103], v[64:79]
  ds_read_b128 v[124:127], v6 offset:15360
  v_mfma_f32_32x32x16_bf16 v[80:95], a[148:151], v[100:103], v[80:95]
  s_add_u32 m0, s38, 4096
  s_add_u32 s17, s28, 4096
  buffer_load_dwordx4 v2, s[8:11], s17 offen offset:0 sc1 lds
  s_waitcnt lgkmcnt(5)
  v_mfma_f32_32x32x16_bf16 v[64:79], a[40:43], v[104:107], v[64:79]
  ds_read_b128 v[96:99], v6 offset:16384
  v_mfma_f32_32x32x16_bf16 v[80:95], a[152:155], v[104:107], v[80:95]
  s_waitcnt lgkmcnt(5)
  v_mfma_f32_32x32x16_bf16 v[64:79], a[44:47], v[108:111], v[64:79]
  ds_read_b128 v[100:103], v6 offset:17408
  v_mfma_f32_32x32x16_bf16 v[80:95], a[156:159], v[108:111], v[80:95]
  buffer_load_dwordx4 v2, s[8:11], s17 offen offset:1024 sc1 lds
  s_waitcnt lgkmcnt(5)
  v_mfma_f32_32x32x16_bf16 v[64:79], a[48:51], v[112:115], v[64:79]
  ds_read_b128 v[104:107], v6 offset:18432
  v_mfma_f32_32x32x16_bf16 v[80:95], a[160:163], v[112:115], v[80:95]
  s_waitcnt lgkmcnt(5)
  v_mfma_f32_32x32x16_bf16 v[64:79], a[52:55], v[116:119], v[64:79]
  ds_read_b128 v[108:111], v6 offset:19456
  v_mfma_f32_32x32x16_bf16 v[80:95], a[164:167], v[116:119], v[80:95]
  buffer_load_dwordx4 v2, s[8:11], s17 offen offset:2048 sc1 lds
  s_add_u32 s28, s28, s29
  s_add_u32 s38, s38, 28672
  s_cmp_ge_u32 s38, 86016
  s_cselect_b32 s17, 86016, 0
  s_sub_u32 s38, s38, s17
  s_waitcnt lgkmcnt(5)
  v_mfma_f32_32x32x16_bf16 v[64:79], a[56:59], v[120:123], v[64:79]
  ds_read_b128 v[112:115], v6 offset:20480
  v_mfma_f32_32x32x16_bf16 v[80:95], a[168:171], v[120:123], v[80:95]
  s_waitcnt lgkmcnt(5)
  v_mfma_f32_32x32x16_bf16 v[64:79], a[60:63], v[124:127], v[64:79]
  ds_read_b128 v[116:119], v6 offset:21504
  v_mfma_f32_32x32x16_bf16 v[80:95], a[172:175], v[124:127], v[80:95]
  s_waitcnt lgkmcnt(5)
  v_mfma_f32_32x32x16_bf16 v[64:79], a[64:67], v[96:99], v[64:79]
  ds_read_b128 v[120:123], v6 offset:22528
  v_mfma_f32_32x32x16_bf16 v[80:95], a[176:179], v[96:99], v[80:95]
  s_waitcnt lgkmcnt(5)
  v_mfma_f32_32x32x16_bf16 v[64:79], a[68:71], v[100:103], v[64:79]
  ds_read_b128 v[124:127], v6 offset:23552
  v_mfma_f32_32x32x16_bf16 v[80:95], a[180:183], v[100:103], v[80:95]
  s_waitcnt lgkmcnt(5)
  v_mfma_f32_32x32x16_bf16 v[64:79], a[72:75], v[104:107], v[64:79]
  ds_read_b128 v[96:99], v6 offset:24576
  v_mfma_f32_32x32x16_bf16 v[80:95], a[184:187], v[104:107], v[80:95]
  s_waitcnt lgkmcnt(5)
  v_mfma_f32_32x32x16_bf16 v[64:79], a[76:79], v[108:111], v[64:79]
  ds_read_b128 v[100:103], v6 offset:25600
  v_mfma_f32_32x32x16_bf16 v[80:95], a[188:191], v[108:111], v[80:95]
  s_waitcnt lgkmcnt(5)
  v_mfma_f32_32x32x16_bf16 v[64:79], a[80:83], v[112:115], v[64:79]
  ds_read_b128 v[104:107], v6 offset:26624
  v_mfma_f32_32x32x16_bf16 v[80:95], a[192:195], v[112:115], v[80:95]
  s_waitcnt lgkmcnt(5)
  v_mfma_f32_32x32x16_bf16 v[64:79], a[84:87], v[116:119], v[64:79]
  ds_read_b128 v[108:111], v6 offset:27648
  v_mfma_f32_32x32x16_bf16 v[80:95], a[196:199], v[116:119], v[80:95]
  s_waitcnt lgkmcnt(5)
  v_mfma_f32_32x32x16_bf16 v[64:79], a[88:91], v[120:123], v[64:79]
  v_mfma_f32_32x32x16_bf16 v[80:95], a[200:203], v[120:123], v[80:95]
  s_waitcnt lgkmcnt(4)
  v_mfma_f32_32x32x16_bf16 v[64:79], a[92:95], v[124:127], v[64:79]
  v_mfma_f32_32x32x16_bf16 v[80:95], a[204:207], v[124:127], v[80:95]
  s_waitcnt lgkmcnt(3)
  v_mfma_f32_32x32x16_bf16 v[64:79], a[96:99], v[96:99], v[64:79]
  v_mfma_f32_32x32x16_bf16 v[80:95], a[208:211], v[96:99], v[80:95]
  s_waitcnt lgkmcnt(2)
  v_mfma_f32_32x32x16_bf16 v[64:79], a[100:103], v[100:103], v[64:79]
  v_mfma_f32_32x32x16_bf16 v[80:95], a[212:215], v[100:103], v[80:95]
  s_waitcnt lgkmcnt(1)
  v_mfma_f32_32x32x16_bf16 v[64:79], a[104:107], v[104:107], v[64:79]
  v_mfma_f32_32x32x16_bf16 v[80:95], a[216:219], v[104:107], v[80:95]
  s_waitcnt lgkmcnt(0)
  v_mfma_f32_32x32x16_bf16 v[64:79], a[108:111], v[108:111], v[64:79]
  v_mfma_f32_32x32x16_bf16 v[80:95], a[220:223], v[108:111], v[80:95]
  s_cmp_lt_u32 s36, s35
  s_cbranch_scc1 EF_top
  s_nop 1
  buffer_store_dwordx4 v[64:67], v2, s[8:11], s30 offen offset:0 sc1
  buffer_store_dwordx4 v[68:71], v2, s[8:11], s30 offen offset:1024 sc1
  buffer_store_dwordx4 v[72:75], v2, s[8:11], s30 offen offset:2048 sc1
  buffer_store_dwordx4 v[76:79], v2, s[8:11], s30 offen offset:3072 sc1
  s_nop 3
  buffer_store_dwordx4 v[80:83], v2, s[8:11], s31 offen offset:0 sc1
  buffer_store_dwordx4 v[84:87], v2, s[8:11], s31 offen offset:1024 sc1
  buffer_store_dwordx4 v[88:91], v2, s[8:11], s31 offen offset:2048 sc1
  buffer_store_dwordx4 v[92:95], v2, s[8:11], s31 offen offset:3072 sc1
  s_add_u32 s30, s30, s32
  s_add_u32 s31, s31, s32
  s_waitcnt vmcnt(0)
  s_barrier
  buffer_atomic_add v5, v4, s[8:11], s33 offen sc1
  s_add_u32 s33, s33, s34
  buffer_atomic_add v5, v4, s[8:11], s33 offen sc1
  s_branch W_next
roleA:
  v_and_b32 v1, 63, v0
  v_lshrrev_b32 v2, 6, v0
  s_nop 0
  v_readfirstlane_b32 s13, v2
  v_and_b32 v2, 15, v1
  v_lshrrev_b32 v3, 4, v1
  v_lshrrev_b32 v6, 1, v3
  v_lshlrev_b32 v4, 10, v6
  v_and_b32 v6, 1, v3
  v_lshl_add_u32 v4, v6, 9, v4
  v_lshl_add_u32 v4, v2, 4, v4
  v_mov_b32 v5, 0x4444
  v_mov_b32 v6, 0xeeee
  v_and_b32 v7, 8, v1
  v_cmp_ne_u32 vcc, 0, v7
  s_nop 1
  v_cndmask_b32 v5, v5, v6, vcc
  v_lshlrev_b32 v14, 2, v1
  v_mov_b32 v15, 0
  s_mov_b32 s25, 262144
  s_mov_b32 s14, 0
  s_mov_b32 s27, 0
  s_mov_b32 s32, 0
  s_mov_b32 s33, 0xff000000
  s_lshl_b32 s23, s13, 1
  s_add_u32 s23, s23, 0
  s_add_u32 s23, s23, s12
  s_cmp_ge_u32 s23, 7
  s_cselect_b32 s24, 7, 0
  s_sub_u32 s23, s23, s24
  s_cmp_ge_u32 s23, 7
  s_cselect_b32 s24, 7, 0
  s_sub_u32 s23, s23, s24
  s_cmp_ge_u32 s23, 7
  s_cselect_b32 s24, 7, 0
  s_sub_u32 s23, s23, s24
  s_cmp_ge_u32 s23, 7
  s_cselect_b32 s24, 7, 0
  s_sub_u32 s23, s23, s24
  s_lshl_b32 s34, s23, 10
  s_lshl_b32 s23, s13, 1
  s_add_u32 s23, s23, 1
  s_add_u32 s23, s23, s12
  s_cmp_ge_u32 s23, 7
  s_cselect_b32 s24, 7, 0
  s_sub_u32 s23, s23, s24
  s_cmp_ge_u32 s23, 7
  s_cselect_b32 s24, 7, 0
  s_sub_u32 s23, s23, s24
  s_cmp_ge_u32 s23, 7
  s_cselect_b32 s24, 7, 0
  s_sub_u32 s23, s23, s24
  s_cmp_ge_u32 s23, 7
  s_cselect_b32 s24, 7, 0
  s_sub_u32 s23, s23, s24
  s_lshl_b32 s35, s23, 10
  s_lshl_b32 s23, s13, 1
  s_add_u32 s23, s23, 2
  s_add_u32 s23, s23, s12
  s_cmp_ge_u32 s23, 7
  s_cselect_b32 s24, 7, 0
  s_sub_u32 s23, s23, s24
  s_cmp_ge_u32 s23, 7
  s_cselect_b32 s24, 7, 0
  s_sub_u32 s23, s23, s24
  s_cmp_ge_u32 s23, 7
  s_cselect_b32 s24, 7, 0
  s_sub_u32 s23, s23, s24
  s_cmp_ge_u32 s23, 7
  s_cselect_b32 s24, 7, 0
  s_sub_u32 s23, s23, s24
  s_lshl_b32 s36, s23, 10
  s_lshl_b32 s23, s13, 1
  s_add_u32 s23, s23, 3
  s_add_u32 s23, s23, s12
  s_cmp_ge_u32 s23, 7
  s_cselect_b32 s24, 7, 0
  s_sub_u32 s23, s23, s24
  s_cmp_ge_u32 s23, 7
  s_cselect_b32 s24, 7, 0
  s_sub_u32 s23, s23, s24
  s_cmp_ge_u32 s23, 7
  s_cselect_b32 s24, 7, 0
  s_sub_u32 s23, s23, s24
  s_cmp_ge_u32 s23, 7
  s_cselect_b32 s24, 7, 0
  s_sub_u32 s23, s23, s24
  s_lshl_b32 s37, s23, 10
  s_lshl_b32 s23, s13, 1
  s_add_u32 s23, s23, 4
  s_add_u32 s23, s23, s12
  s_cmp_ge_u32 s23, 7
  s_cselect_b32 s24, 7, 0
  s_sub_u32 s23, s23, s24
  s_cmp_ge_u32 s23, 7
  s_cselect_b32 s24, 7, 0
  s_sub_u32 s23, s23, s24
  s_cmp_ge_u32 s23, 7
  s_cselect_b32 s24, 7, 0
  s_sub_u32 s23, s23, s24
  s_cmp_ge_u32 s23, 7
  s_cselect_b32 s24, 7, 0
  s_sub_u32 s23, s23, s24
  s_lshl_b32 s38, s23, 10
  s_lshl_b32 s23, s13, 1
  s_add_u32 s23, s23, 5
  s_add_u32 s23, s23, s12
  s_cmp_ge_u32 s23, 7
  s_cselect_b32 s24, 7, 0
  s_sub_u32 s23, s23, s24
  s_cmp_ge_u32 s23, 7
  s_cselect_b32 s24, 7, 0
  s_sub_u32 s23, s23, s24
  s_cmp_ge_u32 s23, 7
  s_cselect_b32 s24, 7, 0
  s_sub_u32 s23, s23, s24
  s_cmp_ge_u32 s23, 7
  s_cselect_b32 s24, 7, 0
  s_sub_u32 s23, s23, s24
  s_lshl_b32 s39, s23, 10
  s_lshl_b32 s23, s13, 1
  s_add_u32 s23, s23, 6
  s_add_u32 s23, s23, s12
  s_cmp_ge_u32 s23, 7
  s_cselect_b32 s24, 7, 0
  s_sub_u32 s23, s23, s24
  s_cmp_ge_u32 s23, 7
  s_cselect_b32 s24, 7, 0
  s_sub_u32 s23, s23, s24
  s_cmp_ge_u32 s23, 7
  s_cselect_b32 s24, 7, 0
  s_sub_u32 s23, s23, s24
  s_cmp_ge_u32 s23, 7
  s_cselect_b32 s24, 7, 0
  s_sub_u32 s23, s23, s24
  s_lshl_b32 s40, s23, 10
  v_lshlrev_b32 v8, 4, v1
  v_add_u32 v6, s34, v8
  v_add_u32 v7, s35, v8
  s_mov_b32 s16, 65536
  s_mov_b32 s18, 524288
  s_mul_i32 s23, s13, 7
  s_add_u32 s23, s23, 0
  s_and_b32 s24, s23, 1
  s_lshl_b32 s24, s24, 8
  s_lshr_b32 s23, s23, 1
  s_mul_i32 s26, s12, 14
  s_add_u32 s23, s23, s26
  s_mul_i32 s23, s23, 28672
  s_add_u32 s23, s23, s24
  s_add_u32 s72, s23, 3719168
  s_mul_i32 s23, s13, 7
  s_add_u32 s23, s23, 1
  s_and_b32 s24, s23, 1
  s_lshl_b32 s24, s24, 8
  s_lshr_b32 s23, s23, 1
  s_mul_i32 s26, s12, 14
  s_add_u32 s23, s23, s26
  s_mul_i32 s23, s23, 28672
  s_add_u32 s23, s23, s24
  s_add_u32 s73, s23, 3719168
  s_mul_i32 s23, s13, 7
  s_add_u32 s23, s23, 2
  s_and_b32 s24, s23, 1
  s_lshl_b32 s24, s24, 8
  s_lshr_b32 s23, s23, 1
  s_mul_i32 s26, s12, 14
  s_add_u32 s23, s23, s26
  s_mul_i32 s23, s23, 28672
  s_add_u32 s23, s23, s24
  s_add_u32 s74, s23, 3719168
  s_mul_i32 s23, s13, 7
  s_add_u32 s23, s23, 3
  s_and_b32 s24, s23, 1
  s_lshl_b32 s24, s24, 8
  s_lshr_b32 s23, s23, 1
  s_mul_i32 s26, s12, 14
  s_add_u32 s23, s23, s26
  s_mul_i32 s23, s23, 28672
  s_add_u32 s23, s23, s24
  s_add_u32 s75, s23, 3719168
  s_mul_i32 s23, s13, 7
  s_add_u32 s23, s23, 4
  s_and_b32 s24, s23, 1
  s_lshl_b32 s24, s24, 8
  s_lshr_b32 s23, s23, 1
  s_mul_i32 s26, s12, 14
  s_add_u32 s23, s23, s26
  s_mul_i32 s23, s23, 28672
  s_add_u32 s23, s23, s24
  s_add_u32 s76, s23, 3719168
  s_mul_i32 s23, s13, 7
  s_add_u32 s23, s23, 5
  s_and_b32 s24, s23, 1
  s_lshl_b32 s24, s24, 8
  s_lshr_b32 s23, s23, 1
  s_mul_i32 s26, s12, 14
  s_add_u32 s23, s23, s26
  s_mul_i32 s23, s23, 28672
  s_add_u32 s23, s23, s24
  s_add_u32 s77, s23, 3719168
  s_mul_i32 s23, s13, 7
  s_add_u32 s23, s23, 6
  s_and_b32 s24, s23, 1
  s_lshl_b32 s24, s24, 8
  s_lshr_b32 s23, s23, 1
  s_mul_i32 s26, s12, 14
  s_add_u32 s23, s23, s26
  s_mul_i32 s23, s23, 28672
  s_add_u32 s23, s23, s24
  s_add_u32 s78, s23, 3719168
  v_and_b32 v115, 7, v1
  v_lshlrev_b32 v115, 2, v115
  s_mul_i32 s24, s13, 7
  s_lshr_b32 s24, s24, 1
  s_lshl_b32 s24, s24, 3
  s_mul_i32 s23, s12, 8704
  s_add_u32 s23, s23, s24
  s_add_u32 s23, s23, 1638400
  v_add_u32 v115, s23, v115
  v_mov_b32 v112, v4
  v_mov_b32 v113, 0
  s_mov_b32 s26, 0
  s_cmp_eq_u32 s35, 0
  s_cbranch_scc1 A_lw_b1
  s_cmp_eq_u32 s36, 0
  s_cbranch_scc1 A_lw_b2
  s_cmp_eq_u32 s37, 0
  s_cbranch_scc1 A_lw_b3
  s_cmp_eq_u32 s38, 0
  s_cbranch_scc1 A_lw_b4
  s_cmp_eq_u32 s39, 0
  s_cbranch_scc1 A_lw_b5
  s_cmp_eq_u32 s40, 0
  s_cbranch_scc1 A_lw_b6
A_lw_b0:
  v_cmp_ge_u32 vcc, s26, v113
  s_cbranch_vccz A_lw_g0
  s_waitcnt vmcnt(14)
A_lw_c0:
  v_cmp_ge_u32 vcc, s26, v113
  s_cbranch_vccz A_lw_g0
  buffer_load_dword v113, v115, s[8:11], 0 offen sc1
  s_sub_u32 s25, s25, 1
  s_cbranch_scc1 abort
  s_sleep 8
  s_waitcnt vmcnt(0)
  s_branch A_lw_c0
A_lw_g0:
  buffer_load_dword v113, v115, s[8:11], 0 offen sc1
  buffer_load_dwordx4 a[0:3], v112, s[8:11], s72 offen offset:0
  buffer_load_dwordx4 a[4:7], v112, s[8:11], s72 offen offset:2048
  buffer_load_dwordx4 a[56:59], v112, s[8:11], s73 offen offset:0
  buffer_load_dwordx4 a[60:63], v112, s[8:11], s73 offen offset:2048
  buffer_load_dwordx4 a[112:115], v112, s[8:11], s74 offen offset:0
  buffer_load_dwordx4 a[116:119], v112, s[8:11], s74 offen offset:2048
  buffer_load_dwordx4 a[168:171], v112, s[8:11], s75 offen offset:0
  buffer_load_dwordx4 a[172:175], v112, s[8:11], s75 offen offset:2048
  buffer_load_dwordx4 a[216:219], v112, s[8:11], s76 offen offset:0
  buffer_load_dwordx4 a[220:223], v112, s[8:11], s76 offen offset:2048
  buffer_load_dwordx4 v[152:155], v112, s[8:11], s77 offen offset:0
  buffer_load_dwordx4 v[156:159], v112, s[8:11], s77 offen offset:2048
  buffer_load_dwordx4 v[208:211], v112, s[8:11], s78 offen offset:0
  buffer_load_dwordx4 v[212:215], v112, s[8:11], s78 offen offset:2048
  v_add_u32 v112, 4096, v112
  s_add_u32 s26, s26, 1
  s_cmp_eq_u32 s26, 7
  s_waitcnt vmcnt(29)
  s_cbranch_scc1 A_lw_done
A_lw_b1:
  v_cmp_ge_u32 vcc, s26, v113
  s_cbranch_vccz A_lw_g1
  s_waitcnt vmcnt(14)
A_lw_c1:
  v_cmp_ge_u32 vcc, s26, v113
  s_cbranch_vccz A_lw_g1
  buffer_load_dword v113, v115, s[8:11], 0 offen sc1
  s_sub_u32 s25, s25, 1
  s_cbranch_scc1 abort
  s_sleep 8
  s_waitcnt vmcnt(0)
  s_branch A_lw_c1
A_lw_g1:
  buffer_load_dword v113, v115, s[8:11], 0 offen sc1
  buffer_load_dwordx4 a[8:11], v112, s[8:11], s72 offen offset:0
  buffer_load_dwordx4 a[12:15], v112, s[8:11], s72 offen offset:2048
  buffer_load_dwordx4 a[64:67], v112, s[8:11], s73 offen offset:0
  buffer_load_dwordx4 a[68:71], v112, s[8:11], s73 offen offset:2048
  buffer_load_dwordx4 a[120:123], v112, s[8:11], s74 offen offset:0
  buffer_load_dwordx4 a[124:127], v112, s[8:11], s74 offen offset:2048
  buffer_load_dwordx4 a[176:179], v112, s[8:11], s75 offen offset:0
  buffer_load_dwordx4 a[180:183], v112, s[8:11], s75 offen offset:2048
  buffer_load_dwordx4 a[224:227], v112, s[8:11], s76 offen offset:0
  buffer_load_dwordx4 a[228:231], v112, s[8:11], s76 offen offset:2048
  buffer_load_dwordx4 v[160:163], v112, s[8:11], s77 offen offset:0
  buffer_load_dwordx4 v[164:167], v112, s[8:11], s77 offen offset:2048
  buffer_load_dwordx4 v[16:19], v112, s[8:11], s78 offen offset:0
  buffer_load_dwordx4 v[20:23], v112, s[8:11], s78 offen offset:2048
  v_add_u32 v112, 4096, v112
  s_add_u32 s26, s26, 1
  s_cmp_eq_u32 s26, 7
  s_waitcnt vmcnt(29)
  s_cbranch_scc1 A_lw_done
A_lw_b2:
  v_cmp_ge_u32 vcc, s26, v113
  s_cbranch_vccz A_lw_g2
  s_waitcnt vmcnt(14)
A_lw_c2:
  v_cmp_ge_u32 vcc, s26, v113
  s_cbranch_vccz A_lw_g2
  buffer_load_dword v113, v115, s[8:11], 0 offen sc1
  s_sub_u32 s25, s25, 1
  s_cbranch_scc1 abort
  s_sleep 8
  s_waitcnt vmcnt(0)
  s_branch A_lw_c2
A_lw_g2:
  buffer_load_dword v113, v115, s[8:11], 0 offen sc1
  buffer_load_dwordx4 a[16:19], v112, s[8:11], s72 offen offset:0
  buffer_load_dwordx4 a[20:23], v112, s[8:11], s72 offen offset:2048
  buffer_load_dwordx4 a[72:75], v112, s[8:11], s73 offen offset:0
  buffer_load_dwordx4 a[76:79], v112, s[8:11], s73 offen offset:2048
  buffer_load_dwordx4 a[128:131], v112, s[8:11], s74 offen offset:0
  buffer_load_dwordx4 a[132:135], v112, s[8:11], s74 offen offset:2048
  buffer_load_dwordx4 a[184:187], v112, s[8:11], s75 offen offset:0
  buffer_load_dwordx4 a[188:191], v112, s[8:11], s75 offen offset:2048
  buffer_load_dwordx4 a[232:235], v112, s[8:11], s76 offen offset:0
  buffer_load_dwordx4 a[236:239], v112, s[8:11], s76 offen offset:2048
  buffer_load_dwordx4 v[168:171], v112, s[8:11], s77 offen offset:0
  buffer_load_dwordx4 v[172:175], v112, s[8:11], s77 offen offset:2048
  buffer_load_dwordx4 v[216:219], v112, s[8:11], s78 offen offset:0
  buffer_load_dwordx4 v[220:223], v112, s[8:11], s78 offen offset:2048
  v_add_u32 v112, 4096, v112
  s_add_u32 s26, s26, 1
  s_cmp_eq_u32 s26, 7
  s_waitcnt vmcnt(29)
  s_cbranch_scc1 A_lw_done
A_lw_b3:
  v_cmp_ge_u32 vcc, s26, v113
  s_cbranch_vccz A_lw_g3
  s_waitcnt vmcnt(14)
A_lw_c3:
  v_cmp_ge_u32 vcc, s26, v113
  s_cbranch_vccz A_lw_g3
  buffer_load_dword v113, v115, s[8:11], 0 offen sc1
  s_sub_u32 s25, s25, 1
  s_cbranch_scc1 abort
  s_sleep 8
  s_waitcnt vmcnt(0)
  s_branch A_lw_c3
A_lw_g3:
  buffer_load_dword v113, v115, s[8:11], 0 offen sc1
  buffer_load_dwordx4 a[24:27], v112, s[8:11], s72 offen offset:0
  buffer_load_dwordx4 a[28:31], v112, s[8:11], s72 offen offset:2048
  buffer_load_dwordx4 a[80:83], v112, s[8:11], s73 offen offset:0
  buffer_load_dwordx4 a[84:87], v112, s[8:11], s73 offen offset:2048
  buffer_load_dwordx4 a[136:139], v112, s[8:11], s74 offen offset:0
  buffer_load_dwordx4 a[140:143], v112, s[8:11], s74 offen offset:2048
  buffer_load_dwordx4 a[192:195], v112, s[8:11], s75 offen offset:0
  buffer_load_dwordx4 a[196:199], v112, s[8:11], s75 offen offset:2048
  buffer_load_dwordx4 a[240:243], v112, s[8:11], s76 offen offset:0
  buffer_load_dwordx4 a[244:247], v112, s[8:11], s76 offen offset:2048
  buffer_load_dwordx4 v[176:179], v112, s[8:11], s77 offen offset:0
  buffer_load_dwordx4 v[180:183], v112, s[8:11], s77 offen offset:2048
  buffer_load_dwordx4 v[224:227], v112, s[8:11], s78 offen offset:0
  buffer_load_dwordx4 v[228:231], v112, s[8:11], s78 offen offset:2048
  v_add_u32 v112, 4096, v112
  s_add_u32 s26, s26, 1
  s_cmp_eq_u32 s26, 7
  s_waitcnt vmcnt(29)
  s_cbranch_scc1 A_lw_done
A_lw_b4:
  v_cmp_ge_u32 vcc, s26, v113
  s_cbranch_vccz A_lw_g4
  s_waitcnt vmcnt(14)
A_lw_c4:
  v_cmp_ge_u32 vcc, s26, v113
  s_cbranch_vccz A_lw_g4
  buffer_load_dword v113, v115, s[8:11], 0 offen sc1
  s_sub_u32 s25, s25, 1
  s_cbranch_scc1 abort
  s_sleep 8
  s_waitcnt vmcnt(0)
  s_branch A_lw_c4
A_lw_g4:
  buffer_load_dword v113, v115, s[8:11], 0 offen sc1
  buffer_load_dwordx4 a[32:35], v112, s[8:11], s72 offen offset:0
  buffer_load_dwordx4 a[36:39], v112, s[8:11], s72 offen offset:2048
  buffer_load_dwordx4 a[88:91], v112, s[8:11], s73 offen offset:0
  buffer_load_dwordx4 a[92:95], v112, s[8:11], s73 offen offset:2048
  buffer_load_dwordx4 a[144:147], v112, s[8:11], s74 offen offset:0
  buffer_load_dwordx4 a[148:151], v112, s[8:11], s74 offen offset:2048
  buffer_load_dwordx4 a[200:203], v112, s[8:11], s75 offen offset:0
  buffer_load_dwordx4 a[204:207], v112, s[8:11], s75 offen offset:2048
  buffer_load_dwordx4 a[248:251], v112, s[8:11], s76 offen offset:0
  buffer_load_dwordx4 a[252:255], v112, s[8:11], s76 offen offset:2048
  buffer_load_dwordx4 v[184:187], v112, s[8:11], s77 offen offset:0
  buffer_load_dwordx4 v[188:191], v112, s[8:11], s77 offen offset:2048
  buffer_load_dwordx4 v[232:235], v112, s[8:11], s78 offen offset:0
  buffer_load_dwordx4 v[236:239], v112, s[8:11], s78 offen offset:2048
  v_add_u32 v112, 4096, v112
  s_add_u32 s26, s26, 1
  s_cmp_eq_u32 s26, 7
  s_waitcnt vmcnt(29)
  s_cbranch_scc1 A_lw_done
A_lw_b5:
  v_cmp_ge_u32 vcc, s26, v113
  s_cbranch_vccz A_lw_g5
  s_waitcnt vmcnt(14)
A_lw_c5:
  v_cmp_ge_u32 vcc, s26, v113
  s_cbranch_vccz A_lw_g5
  buffer_load_dword v113, v115, s[8:11], 0 offen sc1
  s_sub_u32 s25, s25, 1
  s_cbranch_scc1 abort
  s_sleep 8
  s_waitcnt vmcnt(0)
  s_branch A_lw_c5
A_lw_g5:
  buffer_load_dword v113, v115, s[8:11], 0 offen sc1
  buffer_load_dwordx4 a[40:43], v112, s[8:11], s72 offen offset:0
  buffer_load_dwordx4 a[44:47], v112, s[8:11], s72 offen offset:2048
  buffer_load_dwordx4 a[96:99], v112, s[8:11], s73 offen offset:0
  buffer_load_dwordx4 a[100:103], v112, s[8:11], s73 offen offset:2048
  buffer_load_dwordx4 a[152:155], v112, s[8:11], s74 offen offset:0
  buffer_load_dwordx4 a[156:159], v112, s[8:11], s74 offen offset:2048
  buffer_load_dwordx4 a[208:211], v112, s[8:11], s75 offen offset:0
  buffer_load_dwordx4 a[212:215], v112, s[8:11], s75 offen offset:2048
  buffer_load_dwordx4 v[136:139], v112, s[8:11], s76 offen offset:0
  buffer_load_dwordx4 v[140:143], v112, s[8:11], s76 offen offset:2048
  buffer_load_dwordx4 v[192:195], v112, s[8:11], s77 offen offset:0
  buffer_load_dwordx4 v[196:199], v112, s[8:11], s77 offen offset:2048
  buffer_load_dwordx4 v[240:243], v112, s[8:11], s78 offen offset:0
  buffer_load_dwordx4 v[244:247], v112, s[8:11], s78 offen offset:2048
  v_add_u32 v112, 4096, v112
  s_add_u32 s26, s26, 1
  s_cmp_eq_u32 s26, 7
  s_waitcnt vmcnt(29)
  s_cbranch_scc1 A_lw_done
A_lw_b6:
  v_cmp_ge_u32 vcc, s26, v113
  s_cbranch_vccz A_lw_g6
  s_waitcnt vmcnt(14)
A_lw_c6:
  v_cmp_ge_u32 vcc, s26, v113
  s_cbranch_vccz A_lw_g6
  buffer_load_dword v113, v115, s[8:11], 0 offen sc1
  s_sub_u32 s25, s25, 1
  s_cbranch_scc1 abort
  s_sleep 8
  s_waitcnt vmcnt(0)
  s_branch A_lw_c6
A_lw_g6:
  buffer_load_dword v113, v115, s[8:11], 0 offen sc1
  buffer_load_dwordx4 a[48:51], v112, s[8:11], s72 offen offset:0
  buffer_load_dwordx4 a[52:55], v112, s[8:11], s72 offen offset:2048
  buffer_load_dwordx4 a[104:107], v112, s[8:11], s73 offen offset:0
  buffer_load_dwordx4 a[108:111], v112, s[8:11], s73 offen offset:2048
  buffer_load_dwordx4 a[160:163], v112, s[8:11], s74 offen offset:0
  buffer_load_dwordx4 a[164:167], v112, s[8:11], s74 offen offset:2048
  buffer_load_dwordx4 v[24:27], v112, s[8:11], s75 offen offset:0
  buffer_load_dwordx4 v[28:31], v112, s[8:11], s75 offen offset:2048
  buffer_load_dwordx4 v[144:147], v112, s[8:11], s76 offen offset:0
  buffer_load_dwordx4 v[148:151], v112, s[8:11], s76 offen offset:2048
  buffer_load_dwordx4 v[200:203], v112, s[8:11], s77 offen offset:0
  buffer_load_dwordx4 v[204:207], v112, s[8:11], s77 offen offset:2048
  buffer_load_dwordx4 v[248:251], v112, s[8:11], s78 offen offset:0
  buffer_load_dwordx4 v[252:255], v112, s[8:11], s78 offen offset:2048
  v_add_u32 v112, 4096, v112
  s_add_u32 s26, s26, 1
  s_cmp_eq_u32 s26, 7
  s_waitcnt vmcnt(29)
  s_cbranch_scc1 A_lw_done
  s_branch A_lw_b0
A_lw_done:
  s_bfe_u32 s20, s2, 0x40003
  s_mul_i32 s20, s20, 4352
  s_add_u32 s20, s20, 1812480
  v_and_b32 v44, 7, v1
  v_lshl_add_u32 v44, v44, 2, s20
  buffer_load_dword v45, v44, s[8:11], 0 offen sc1
  buffer_load_dword v46, v14, s[4:7], 0 offen sc1
  s_waitcnt vmcnt(16)
  s_lshl_b32 s23, s13, 12
  s_add_u32 s23, s23, 38912
  v_add_u32 v13, s23, v8
  s_mul_i32 s23, s13, 1792
  v_add_u32 v9, s23, v8
  v_cmp_eq_u32 vcc, 3, v3
  v_mov_b32 v112, 1024
  v_mov_b32 v113, 768
  v_cndmask_b32 v10, v112, v113, vcc
  v_add_u32 v10, v10, v9
  v_and_b32 v112, 3, v2
  v_bfe_u32 v113, v2, 2, 1
  v_lshl_add_u32 v112, v113, 3, v112
  v_bfe_u32 v113, v2, 3, 1
  v_lshl_add_u32 v112, v113, 2, v112
  v_mul_u32_u24 v11, 40, v112
  v_lshl_add_u32 v11, v3, 3, v11
  s_mul_i32 s23, s13, 5120
  s_add_u32 s23, s23, 8192
  v_add_u32 v11, s23, v11
  v_lshrrev_b32 v112, 2, v2
  v_lshl_add_u32 v112, v3, 3, v112
  v_mul_u32_u24 v12, 40, v112
  v_and_b32 v112, 3, v2
  v_lshl_add_u32 v12, v112, 3, v12
  v_add_u32 v12, s23, v12
  v_mov_b32 v114, 0
  v_mov_b32 v115, 0
  v_lshlrev_b32 v112, 3, v1
  v_add_u32 v112, s23, v112
  ds_write_b64 v112, v[114:115] offset:4480
  ds_write_b64 v112, v[114:115] offset:4608
  s_mul_i32 s23, s13, 7168
  v_add_u32 v109, s23, v4
  v_mov_b32 v112, 0x7f000000
  v_cmp_gt_u32 vcc, 2, v3
  s_nop 1
  v_cndmask_b32 v110, v112, v109, vcc
  s_mul_i32 s23, s13, 2560
  s_add_u32 s23, s23, 28672
  v_and_b32 v112, 7, v1
  v_mul_u32_u24 v105, 272, v112
  v_add_u32 v105, s23, v105
  v_lshrrev_b32 v112, 3, v1
  v_min_u32 v112, 5, v112
  v_lshl_add_u32 v112, v112, 4, v105
  v_mov_b32 v116, 0xff800000
  v_mov_b32 v117, 0xff800000
  v_mov_b32 v118, 0xff800000
  v_mov_b32 v119, 0xff800000
  ds_write_b128 v112, v[116:119] offset:160
  v_bfe_u32 v112, v1, 4, 1
  v_lshl_add_u32 v106, v112, 4, v105
  v_bfe_u32 v112, v1, 3, 1
  v_lshl_add_u32 v106, v112, 3, v106
  v_bfe_u32 v113, v1, 5, 1
  v_lshl_add_u32 v106, v113, 2, v106
  v_add_u32 v106, 128, v106
  v_lshl_add_u32 v105, v112, 6, v105
  v_lshl_add_u32 v105, v3, 4, v105
  s_mul_i32 s23, s13, 544
  s_add_u32 s23, s23, 28672
  v_mul_u32_u24 v107, 272, v113
  v_and_b32 v112, 31, v1
  v_lshl_add_u32 v107, v112, 3, v107
  v_add_u32 v107, s23, v107
  v_bfe_u32 v112, v1, 3, 1
  v_lshlrev_b32 v108, 8, v112
  v_and_b32 v112, 1, v1
  v_lshl_add_u32 v108, v112, 7, v108
  v_bfe_u32 v112, v1, 1, 1
  v_lshl_add_u32 v108, v112, 3, v108
  v_bfe_u32 v112, v1, 2, 1
  v_lshl_add_u32 v108, v112, 2, v108
  s_lshl_b32 s23, s12, 9
  v_add_u32 v108, s23, v108
  s_lshl_b32 s23, s12, 7
  s_add_u32 s23, s23, 8192
  v_lshlrev_b32 v112, 2, v2
  v_add_u32 v112, s23, v112
  v_mov_b32 v114, 0x7f000000
  v_cmp_gt_u32 vcc, 4, v2
  s_nop 1
  v_cndmask_b32 v112, v114, v112, vcc
  v_and_b32 v114, 16, v1
  v_cmp_eq_u32 vcc, 0, v114
  s_nop 1
  v_cndmask_b32 v108, v112, v108, vcc
  s_lshl_b32 s23, s13, 5
  v_lshl_add_u32 v108, v113, 4, v108
  v_add_u32 v108, s23, v108
  v_min_u32 v112, 55, v1
  v_lshlrev_b32 v3, 2, v112
  s_lshr_b32 s23, s12, 2
  s_lshl_b32 s23, s23, 8
  s_add_u32 s23, s23, 43008
  v_add_u32 v3, s23, v3
  s_lshl_b32 s23, s12, 2
  s_add_u32 s23, s23, 40960
  v_cmp_gt_u32 vcc, 14, v0
  v_lshlrev_b32 v0, 7, v1
  v_add_u32 v0, s23, v0
  v_mov_b32 v112, 0x7f000000
  v_cndmask_b32 v0, v112, v0, vcc
  s_mov_b32 s17, 1884160
  v_add_u32 v2, s36, v8
  v_add_u32 v111, s37, v8
  s_cmp_eq_u32 0, 0
  s_branch A_rw0
A_rwx:
  s_waitcnt vmcnt(0)
  s_branch A_mode_cx_chk
A_mode_cx:
  buffer_load_dword v45, v44, s[8:11], 0 offen sc1
  s_waitcnt vmcnt(0)
A_mode_cx_chk:
  v_cmp_gt_u32 vcc, 32, v45
  s_cbranch_vccz A_mode_cx_ok
  s_sub_u32 s25, s25, 1
  s_cbranch_scc1 abort
  s_sleep 8
  s_branch A_mode_cx
A_mode_cx_ok:
  s_branch A_mode_chk
A_mode:
  buffer_load_dword v46, v14, s[4:7], 0 offen sc1
  s_waitcnt vmcnt(0)
A_mode_chk:
  v_and_b32 v47, 0xff, v46
  v_cmp_gt_u32 vcc, 32, v47
  s_nop 0
  s_and_b32 vcc_lo, vcc_lo, 0x10
  s_and_b32 vcc_hi, vcc_hi, 0x0
  s_or_b32 vcc_lo, vcc_lo, vcc_hi
  s_cbranch_scc0 A_mode_ok
  s_sub_u32 s25, s25, 1
  s_cbranch_scc1 abort
  s_sleep 8
  s_branch A_mode
A_mode_ok:
  v_readlane_b32 s21, v46, 4
  s_lshl_b32 s15, s15, 5
  s_sub_u32 s15, s15, s21
  s_cmp_lg_u32 s15, 0
  s_cselect_b32 s29, 0x7f000000, 0
  ds_write_b128 v13, v[16:19] offset:0
  ds_write_b128 v13, v[20:23] offset:1024
  ds_write_b128 v13, v[24:27] offset:2048
  ds_write_b128 v13, v[28:31] offset:3072
  s_waitcnt lgkmcnt(0)
  s_barrier
.p2align 5
A_step:
  s_add_u32 s23, s17, 4096
  buffer_load_dwordx4 v[84:87], v109, s[8:11], s17 offen offset:0
  buffer_load_dwordx4 v[88:91], v109, s[8:11], s17 offen offset:256
  buffer_load_dwordx4 v[92:95], v109, s[8:11], s17 offen offset:2048
  buffer_load_dwordx4 v[96:99], v109, s[8:11], s17 offen offset:2304
  buffer_load_dwordx4 v[120:123], v109, s[8:11], s23 offen offset:0
  buffer_load_dwordx4 v[124:127], v109, s[8:11], s23 offen offset:256
  buffer_load_dwordx4 v[128:131], v110, s[8:11], s23 offen offset:2048
  buffer_load_dwordx4 v[132:135], v110, s[8:11], s23 offen offset:2304
  s_add_u32 s17, s17, 28672
  ds_read_b128 v[72:75], v13 offset:0
  ds_read_b128 v[76:79], v13 offset:1024
  v_add_u32 v116, s38, v8
  v_add_u32 v117, s39, v8
  v_add_u32 v118, s40, v8
  s_add_u32 s31, s14, 1
  s_add_u32 s30, s18, s29
  v_mov_b32 v4, s31
  s_cmp_eq_u32 s14, 0
  s_cbranch_scc1 A_nsl
  s_sleep 7
A_nsl:
  buffer_load_dword v100, v3, s[8:11], 0 offen sc1
  v_mov_b32 v44, 0
  v_mov_b32 v45, 0
  v_mov_b32 v46, 0
  v_mov_b32 v47, 0
  v_mov_b32 v48, 0
  v_mov_b32 v49, 0
  v_mov_b32 v50, 0
  v_mov_b32 v51, 0
  v_mov_b32 v52, 0
  v_mov_b32 v53, 0
  v_mov_b32 v54, 0
  v_mov_b32 v55, 0
  v_mov_b32 v56, 0
  v_mov_b32 v57, 0
  v_mov_b32 v58, 0
  v_mov_b32 v59, 0
  buffer_load_dword v101, v3, s[8:11], 0 offen sc1
  v_mov_b32 v60, 0
  v_mov_b32 v61, 0
  v_mov_b32 v62, 0
  v_mov_b32 v63, 0
  v_mov_b32 v64, 0
  v_mov_b32 v65, 0
  v_mov_b32 v66, 0
  v_mov_b32 v67, 0
  v_mov_b32 v68, 0
  v_mov_b32 v69, 0
  v_mov_b32 v70, 0
  v_mov_b32 v71, 0
  v_mov_b32 v80, 0
  v_mov_b32 v81, 0
  v_mov_b32 v82, 0
  v_mov_b32 v83, 0
  buffer_load_dword v102, v3, s[8:11], 0 offen sc1
.p2align 5
  s_nop 0
  s_nop 0
  s_nop 0
A_fl:
  s_waitcnt vmcnt(2)
  v_cmp_gt_u32 vcc, s14, v100
  s_cbranch_vccz A_fl_ok
  buffer_load_dword v100, v3, s[8:11], 0 offen sc1
  s_waitcnt vmcnt(2)
  v_cmp_gt_u32 vcc, s14, v101
  s_cbranch_vccz A_fl_ok
  buffer_load_dword v101, v3, s[8:11], 0 offen sc1
  s_waitcnt vmcnt(2)
  v_cmp_gt_u32 vcc, s14, v102
  s_cbranch_vccz A_fl_ok
  buffer_load_dword v102, v3, s[8:11], 0 offen sc1
  s_sub_u32 s25, s25, 1
  s_cbranch_scc0 A_fl
  s_branch abort
.p2align 5
  s_nop 0
  s_nop 0
  s_nop 0
  s_nop 0
  s_nop 0
  s_nop 0
A_fl_ok:
  s_nop 4
  buffer_load_dwordx4 v[16:19], v6, s[8:11], s16 offen
  buffer_load_dwordx4 v[20:23], v7, s[8:11], s16 offen
  s_waitcnt vmcnt(1)
  v_smfmac_f32_16x16x64_bf16 v[44:47], v[16:19], a[0:7], v5
  buffer_load_dwordx4 v[24:27], v2, s[8:11], s16 offen
  v_smfmac_f32_16x16x64_bf16 v[48:51], v[16:19], a[56:63], v5
  buffer_load_dwordx4 v[28:31], v111, s[8:11], s16 offen
  v_smfmac_f32_16x16x64_bf16 v[52:55], v[16:19], a[112:119], v5
  buffer_load_dwordx4 v[32:35], v116, s[8:11], s16 offen
  v_smfmac_f32_16x16x64_bf16 v[56:59], v[16:19], a[168:175], v5
  buffer_load_dwordx4 v[36:39], v117, s[8:11], s16 offen
  v_smfmac_f32_16x16x64_bf16 v[60:63], v[16:19], a[216:223], v5
  buffer_load_dwordx4 v[40:43], v118, s[8:11], s16 offen
A_poll:
  v_smfmac_f32_16x16x64_bf16 v[64:67], v[16:19], v[152:159], v5
  v_smfmac_f32_16x16x64_bf16 v[68:71], v[16:19], v[208:215], v5
  s_waitcnt vmcnt(5)
  s_waitcnt lgkmcnt(0)
  v_smfmac_f32_16x16x64_bf16 v[44:47], v[20:23], a[8:15], v5
  v_smfmac_f32_16x16x64_bf16 v[48:51], v[20:23], a[64:71], v5
  v_smfmac_f32_16x16x64_bf16 v[52:55], v[20:23], a[120:127], v5
  v_smfmac_f32_16x16x64_bf16 v[56:59], v[20:23], a[176:183], v5
  v_smfmac_f32_16x16x64_bf16 v[60:63], v[20:23], a[224:231], v5
  v_smfmac_f32_16x16x64_bf16 v[64:67], v[20:23], v[160:167], v5
  v_smfmac_f32_16x16x64_bf16 v[68:71], v[20:23], v[72:79], v5
  s_waitcnt vmcnt(4)
  v_smfmac_f32_16x16x64_bf16 v[44:47], v[24:27], a[16:23], v5
  ds_read_b128 v[72:75], v13 offset:2048
  v_smfmac_f32_16x16x64_bf16 v[48:51], v[24:27], a[72:79], v5
  ds_read_b128 v[76:79], v13 offset:3072
  v_smfmac_f32_16x16x64_bf16 v[52:55], v[24:27], a[128:135], v5
  v_max3_u32 v104, v16, v20, v24
  v_smfmac_f32_16x16x64_bf16 v[56:59], v[24:27], a[184:191], v5
  v_smfmac_f32_16x16x64_bf16 v[60:63], v[24:27], a[232:239], v5
  v_smfmac_f32_16x16x64_bf16 v[64:67], v[24:27], v[168:175], v5
  s_waitcnt vmcnt(2)
  v_smfmac_f32_16x16x64_bf16 v[68:71], v[24:27], v[216:223], v5
  v_max3_u32 v104, v104, v28, v32
  v_smfmac_f32_16x16x64_bf16 v[44:47], v[28:31], a[24:31], v5
  s_waitcnt vmcnt(0) lgkmcnt(0)
  v_smfmac_f32_16x16x64_bf16 v[44:47], v[32:35], a[32:39], v5
  v_max3_u32 v104, v104, v36, v40
  v_smfmac_f32_16x16x64_bf16 v[44:47], v[36:39], a[40:47], v5
  v_cmp_eq_u32 vcc, -1, v104
  v_smfmac_f32_16x16x64_bf16 v[44:47], v[40:43], a[48:55], v5
  s_cbranch_vccnz A_retry
  v_smfmac_f32_16x16x64_bf16 v[48:51], v[28:31], a[80:87], v5
  buffer_load_dwordx4 v[16:19], v9, s[8:11], s16 offen sc1
  v_smfmac_f32_16x16x64_bf16 v[48:51], v[32:35], a[88:95], v5
  v_cvt_pk_bf16_f32 v100, v44, v45
  v_smfmac_f32_16x16x64_bf16 v[48:51], v[36:39], a[96:103], v5
  v_cvt_pk_bf16_f32 v101, v46, v47
  v_smfmac_f32_16x16x64_bf16 v[48:51], v[40:43], a[104:111], v5
  ds_write_b64 v11, v[100:101] offset:0
  v_smfmac_f32_16x16x64_bf16 v[52:55], v[28:31], a[136:143], v5
  buffer_load_dwordx4 v[20:23], v10, s[8:11], s16 offen sc1
  v_smfmac_f32_16x16x64_bf16 v[52:55], v[32:35], a[144:151], v5
  v_cvt_pk_bf16_f32 v102, v48, v49
  v_smfmac_f32_16x16x64_bf16 v[52:55], v[36:39], a[152:159], v5
  v_cvt_pk_bf16_f32 v103, v50, v51
  v_smfmac_f32_16x16x64_bf16 v[52:55], v[40:43], a[160:167], v5
  ds_write_b64 v11, v[102:103] offset:640
  v_smfmac_f32_16x16x64_bf16 v[56:59], v[28:31], a[192:199], v5
  ds_read_b64_tr_b16 v[44:45], v12 offset:0
  v_smfmac_f32_16x16x64_bf16 v[56:59], v[32:35], a[200:207], v5
  ds_read_b64_tr_b16 v[46:47], v12 offset:160
  v_smfmac_f32_16x16x64_bf16 v[56:59], v[36:39], a[208:215], v5
  v_cvt_pk_bf16_f32 v100, v52, v53
  v_smfmac_f32_16x16x64_bf16 v[56:59], v[40:43], v[72:79], v5
  v_cvt_pk_bf16_f32 v101, v54, v55
  v_smfmac_f32_16x16x64_bf16 v[60:63], v[28:31], a[240:247], v5
  ds_write_b64 v11, v[100:101] offset:1280
  v_smfmac_f32_16x16x64_bf16 v[60:63], v[32:35], a[248:255], v5
  v_cvt_pk_bf16_f32 v102, v56, v57
  v_smfmac_f32_16x16x64_bf16 v[60:63], v[36:39], v[136:143], v5
  v_cvt_pk_bf16_f32 v103, v58, v59
  v_smfmac_f32_16x16x64_bf16 v[60:63], v[40:43], v[144:151], v5
  ds_write_b64 v11, v[102:103] offset:1920
  v_smfmac_f32_16x16x64_bf16 v[64:67], v[28:31], v[176:183], v5
  ds_read_b64_tr_b16 v[48:49], v12 offset:1280
  v_smfmac_f32_16x16x64_bf16 v[64:67], v[32:35], v[184:191], v5
  ds_read_b64_tr_b16 v[50:51], v12 offset:1440
  v_smfmac_f32_16x16x64_bf16 v[64:67], v[36:39], v[192:199], v5
  v_cvt_pk_bf16_f32 v100, v60, v61
  v_smfmac_f32_16x16x64_bf16 v[64:67], v[40:43], v[200:207], v5
  v_cvt_pk_bf16_f32 v101, v62, v63
  v_smfmac_f32_16x16x64_bf16 v[68:71], v[28:31], v[224:231], v5
  ds_write_b64 v11, v[100:101] offset:2560
  v_smfmac_f32_16x16x64_bf16 v[68:71], v[32:35], v[232:239], v5
  v_cvt_pk_bf16_f32 v102, v64, v65
  v_smfmac_f32_16x16x64_bf16 v[68:71], v[36:39], v[240:247], v5
  v_cvt_pk_bf16_f32 v103, v66, v67
  v_smfmac_f32_16x16x64_bf16 v[68:71], v[40:43], v[248:255], v5
  ds_write_b64 v11, v[102:103] offset:3200
  s_waitcnt lgkmcnt(2)
  v_mfma_f32_16x16x32_bf16 v[72:75], v[84:87], v[44:47], 0
  ds_read_b64_tr_b16 v[52:53], v12 offset:2560
  ds_read_b64_tr_b16 v[54:55], v12 offset:2720
  v_mfma_f32_16x16x32_bf16 v[76:79], v[88:91], v[44:47], 0
  v_cvt_pk_bf16_f32 v100, v68, v69
  v_cvt_pk_bf16_f32 v101, v70, v71
  ds_write_b64 v11, v[100:101] offset:3840
  ds_read_b64_tr_b16 v[56:57], v12 offset:3840
  ds_read_b64_tr_b16 v[58:59], v12 offset:4000
  v_mfma_f32_16x16x32_bf16 v[72:75], v[92:95], v[48:51], v[72:75]
  v_mfma_f32_16x16x32_bf16 v[76:79], v[96:99], v[48:51], v[76:79]
  s_waitcnt vmcnt(0)
  v_smfmac_f32_16x16x64_bf16 v[80:83], v[16:19], v[44:51], v5
  s_waitcnt lgkmcnt(3)
  v_mfma_f32_16x16x32_bf16 v[72:75], v[120:123], v[52:55], v[72:75]
  v_mfma_f32_16x16x32_bf16 v[76:79], v[124:127], v[52:55], v[76:79]
  s_waitcnt lgkmcnt(0)
  v_smfmac_f32_16x16x64_bf16 v[80:83], v[20:23], v[52:59], v5
  v_mfma_f32_16x16x32_bf16 v[72:75], v[128:131], v[56:59], v[72:75]
  v_mfma_f32_16x16x32_bf16 v[76:79], v[132:135], v[56:59], v[76:79]
  s_cmp_lg_u32 s15, 0
  v_add_f32_dpp v100, v80, v80 row_ror:8 row_mask:0xf bank_mask:0x3
  v_add_f32_dpp v101, v81, v81 row_ror:8 row_mask:0xf bank_mask:0x3
  s_nop 0
  v_add_f32_dpp v100, v82, v82 row_ror:8 row_mask:0xf bank_mask:0xc
  v_add_f32_dpp v101, v83, v83 row_ror:8 row_mask:0xf bank_mask:0xc
  v_add_f32_dpp v72, v72, v72 row_ror:8 row_mask:0xf bank_mask:0x3
  v_add_f32_dpp v73, v73, v73 row_ror:8 row_mask:0xf bank_mask:0x3
  v_permlane32_swap_b32 v100, v101
  v_add_f32_dpp v74, v74, v74 row_ror:8 row_mask:0xf bank_mask:0x3
  v_add_f32_dpp v75, v75, v75 row_ror:8 row_mask:0xf bank_mask:0x3
  v_add_f32 v100, v100, v101
  v_add_f32_dpp v72, v76, v76 row_ror:8 row_mask:0xf bank_mask:0xc
  ds_write_b32 v106, v100
  v_add_f32_dpp v73, v77, v77 row_ror:8 row_mask:0xf bank_mask:0xc
  v_add_f32_dpp v74, v78, v78 row_ror:8 row_mask:0xf bank_mask:0xc
  v_add_f32_dpp v75, v79, v79 row_ror:8 row_mask:0xf bank_mask:0xc
  ds_write_b128 v105, v[72:75]
  s_waitcnt lgkmcnt(0)
  s_barrier
  ds_read2st64_b64 v[112:115], v107 offset0:0 offset1:5
  ds_read2st64_b64 v[116:119], v107 offset0:10 offset1:15
  s_waitcnt lgkmcnt(1)
  v_pk_add_f32 v[112:113], v[112:113], v[114:115]
  s_waitcnt lgkmcnt(0)
  v_pk_add_f32 v[116:117], v[116:117], v[118:119]
  v_pk_add_f32 v[112:113], v[112:113], v[116:117]
  v_max_f32 v114, v112, v113
  s_nop 1
  v_max_f32_dpp v114, v114, v114 quad_perm:[1,0,3,2] row_mask:0xf bank_mask:0xf
  s_nop 1
  v_max_f32_dpp v114, v114, v114 quad_perm:[2,3,0,1] row_mask:0xf bank_mask:0xf
  s_nop 1
  v_max_f32_dpp v114, v114, v114 row_half_mirror row_mask:0xf bank_mask:0xf
  s_nop 1
  v_max_f32_dpp v114, v114, v114 row_mirror row_mask:0xf bank_mask:0xf
  v_mov_b32 v115, v114
  buffer_store_dword v4, v0, s[8:11], s29 offen
  s_nop 0
  v_permlane16_swap_b32 v114, v115
  v_max_f32 v114, v114, v115
  v_pk_add_f32 v[112:113], v[112:113], v[114:115] op_sel_hi:[1,0] neg_lo:[0,1] neg_hi:[0,1]
  v_exp_f32 v112, v112
  v_exp_f32 v113, v113
  s_nop 0
  v_add_f32 v114, v112, v113
  s_nop 1
  v_add_f32_dpp v114, v114, v114 quad_perm:[1,0,3,2] row_mask:0xf bank_mask:0xf
  s_nop 1
  v_add_f32_dpp v114, v114, v114 quad_perm:[2,3,0,1] row_mask:0xf bank_mask:0xf
  s_nop 1
  v_add_f32_dpp v114, v114, v114 row_half_mirror row_mask:0xf bank_mask:0xf
  s_nop 1
  v_add_f32_dpp v114, v114, v114 row_mirror row_mask:0xf bank_mask:0xf
  v_mov_b32 v115, v114
  s_nop 1
  v_permlane16_swap_b32 v114, v115
  v_add_f32 v114, v114, v115
  v_rcp_f32 v114, v114
  s_nop 0
  v_pk_mul_f32 v[112:113], v[112:113], v[114:115] op_sel_hi:[1,0]
  v_cvt_pk_bf16_f32 v112, v112, v113
  buffer_store_dword v112, v108, s[8:11], s30 offen
  s_cbranch_scc1 A_ps_slow
A_ps_done:
  s_add_u32 s14, s14, 1
  s_add_u32 s16, s16, 7168
  s_add_u32 s18, s18, 10240
  s_cmp_lt_u32 s14, 63
  s_cbranch_scc1 A_step
  s_waitcnt vmcnt(0)
  s_endpgm
A_retry:
  s_sub_u32 s25, s25, 1
  s_cbranch_scc1 abort
A_rw0:
  s_cbranch_scc1 A_rw1
  s_nop 5
  buffer_load_dwordx4 v[16:19], v6, s[8:11], s16 offen sc1
  buffer_load_dwordx4 v[20:23], v7, s[8:11], s16 offen sc1
  buffer_load_dwordx4 v[24:27], v2, s[8:11], s16 offen sc1
  buffer_load_dwordx4 v[28:31], v111, s[8:11], s16 offen sc1
  buffer_load_dwordx4 v[32:35], v116, s[8:11], s16 offen sc1
  buffer_load_dwordx4 v[36:39], v117, s[8:11], s16 offen sc1
A_rw1:
  s_cbranch_scc1 A_rw2
  buffer_load_dwordx4 v[40:43], v118, s[8:11], s16 offen sc1
  ds_read_b128 v[72:75], v13 offset:0
  ds_read_b128 v[76:79], v13 offset:1024
  v_mov_b32 v44, 0
  v_mov_b32 v45, 0
  v_mov_b32 v46, 0
  v_mov_b32 v47, 0
  v_mov_b32 v48, 0
  v_mov_b32 v49, 0
  v_mov_b32 v50, 0
A_rw2:
  s_cbranch_scc1 A_rw3
  v_mov_b32 v51, 0
  v_mov_b32 v52, 0
  v_mov_b32 v53, 0
  v_mov_b32 v54, 0
  v_mov_b32 v55, 0
  v_mov_b32 v56, 0
  v_mov_b32 v57, 0
  v_mov_b32 v58, 0
  v_mov_b32 v59, 0
  v_mov_b32 v60, 0
  v_mov_b32 v61, 0
  v_mov_b32 v62, 0
  v_mov_b32 v63, 0
A_rw3:
  s_cbranch_scc1 A_rw4
  v_mov_b32 v64, 0
  v_mov_b32 v65, 0
  v_mov_b32 v66, 0
  v_mov_b32 v67, 0
  v_mov_b32 v68, 0
  v_mov_b32 v69, 0
  v_mov_b32 v70, 0
  v_mov_b32 v71, 0
  s_waitcnt vmcnt(6)
  v_smfmac_f32_16x16x64_bf16 v[44:47], v[16:19], a[0:7], v5
  v_smfmac_f32_16x16x64_bf16 v[48:51], v[16:19], a[56:63], v5
A_rw4:
  s_cbranch_scc1 A_rw5
  v_smfmac_f32_16x16x64_bf16 v[52:55], v[16:19], a[112:119], v5
  v_smfmac_f32_16x16x64_bf16 v[56:59], v[16:19], a[168:175], v5
  v_smfmac_f32_16x16x64_bf16 v[60:63], v[16:19], a[216:223], v5
A_rw5:
  s_cbranch_scc1 A_rwx
  s_branch A_poll
A_ps_slow:
  buffer_store_dword v112, v108, s[8:11], s18 offen sc1
  buffer_store_dword v4, v0, s[8:11], 0 offen sc1
  s_branch A_ps_done
roleB:
  v_and_b32 v1, 63, v0
  v_lshrrev_b32 v2, 6, v0
  s_nop 0
  v_readfirstlane_b32 s13, v2
  v_and_b32 v2, 15, v1
  v_lshrrev_b32 v3, 4, v1
  v_lshrrev_b32 v6, 1, v3
  v_lshlrev_b32 v4, 10, v6
  v_and_b32 v6, 1, v3
  v_lshl_add_u32 v4, v6, 9, v4
  v_lshl_add_u32 v4, v2, 4, v4
  v_mov_b32 v5, 0x4444
  v_mov_b32 v6, 0xeeee
  v_and_b32 v7, 8, v1
  v_cmp_ne_u32 vcc, 0, v7
  s_nop 1
  v_cndmask_b32 v5, v5, v6, vcc
  v_lshlrev_b32 v14, 2, v1
  v_mov_b32 v15, 0
  s_mov_b32 s25, 262144
  s_mov_b32 s14, 0
  s_mov_b32 s27, 0
  s_mov_b32 s32, 0
  s_mov_b32 s33, 0xff000000
  s_lshl_b32 s23, s13, 1
  s_add_u32 s23, s23, 0
  s_cmp_ge_u32 s23, 7
  s_cselect_b32 s24, 7, 0
  s_sub_u32 s23, s23, s24
  s_lshl_b32 s34, s23, 10
  s_lshl_b32 s23, s13, 1
  s_add_u32 s23, s23, 1
  s_cmp_ge_u32 s23, 7
  s_cselect_b32 s24, 7, 0
  s_sub_u32 s23, s23, s24
  s_lshl_b32 s35, s23, 10
  s_lshl_b32 s23, s13, 1
  s_add_u32 s23, s23, 2
  s_cmp_ge_u32 s23, 7
  s_cselect_b32 s24, 7, 0
  s_sub_u32 s23, s23, s24
  s_lshl_b32 s36, s23, 10
  s_lshl_b32 s23, s13, 1
  s_add_u32 s23, s23, 3
  s_cmp_ge_u32 s23, 7
  s_cselect_b32 s24, 7, 0
  s_sub_u32 s23, s23, s24
  s_lshl_b32 s37, s23, 10
  s_lshl_b32 s23, s13, 1
  s_add_u32 s23, s23, 4
  s_cmp_ge_u32 s23, 7
  s_cselect_b32 s24, 7, 0
  s_sub_u32 s23, s23, s24
  s_lshl_b32 s38, s23, 10
  s_lshl_b32 s23, s13, 1
  s_add_u32 s23, s23, 5
  s_cmp_ge_u32 s23, 7
  s_cselect_b32 s24, 7, 0
  s_sub_u32 s23, s23, s24
  s_lshl_b32 s39, s23, 10
  s_lshl_b32 s23, s13, 1
  s_add_u32 s23, s23, 6
  s_cmp_ge_u32 s23, 7
  s_cselect_b32 s24, 7, 0
  s_sub_u32 s23, s23, s24
  s_lshl_b32 s40, s23, 10
  v_lshlrev_b32 v8, 4, v1
  v_add_u32 v6, s34, v8
  v_add_u32 v7, s35, v8
  s_mov_b32 s16, 65536
  s_mov_b32 s18, 524288
  s_mul_i32 s23, s13, 24576
  s_add_u32 s28, s23, 12288
  v_add_u32 v13, s28, v8
  s_lshl_b32 s23, s13, 2
  s_add_u32 s23, s23, 16
  s_mul_i32 s23, s23, 14
  s_add_u32 s23, s23, s12
  s_mul_i32 s23, s23, 28672
  s_add_u32 s72, s23, 3719168
  s_lshl_b32 s23, s13, 2
  s_add_u32 s23, s23, 16
  s_mul_i32 s23, s23, 14
  s_add_u32 s23, s23, s12
  s_mul_i32 s23, s23, 28672
  s_add_u32 s73, s23, 3719424
  s_lshl_b32 s23, s13, 2
  s_add_u32 s23, s23, 17
  s_mul_i32 s23, s23, 14
  s_add_u32 s23, s23, s12
  s_mul_i32 s23, s23, 28672
  s_add_u32 s74, s23, 3719168
  s_lshl_b32 s23, s13, 2
  s_add_u32 s23, s23, 17
  s_mul_i32 s23, s23, 14
  s_add_u32 s23, s23, s12
  s_mul_i32 s23, s23, 28672
  s_add_u32 s75, s23, 3719424
  s_lshl_b32 s23, s13, 2
  s_add_u32 s23, s23, 18
  s_mul_i32 s23, s23, 14
  s_add_u32 s23, s23, s12
  s_mul_i32 s23, s23, 28672
  s_add_u32 s76, s23, 3719168
  s_lshl_b32 s23, s13, 2
  s_add_u32 s23, s23, 18
  s_mul_i32 s23, s23, 14
  s_add_u32 s23, s23, s12
  s_mul_i32 s23, s23, 28672
  s_add_u32 s77, s23, 3719424
  s_lshl_b32 s23, s13, 2
  s_add_u32 s23, s23, 19
  s_mul_i32 s23, s23, 14
  s_add_u32 s23, s23, s12
  s_mul_i32 s23, s23, 28672
  s_add_u32 s78, s23, 3719168
  s_lshl_b32 s23, s13, 2
  s_add_u32 s23, s23, 19
  s_mul_i32 s23, s23, 14
  s_add_u32 s23, s23, s12
  s_mul_i32 s23, s23, 28672
  s_add_u32 s79, s23, 3719424
  v_and_b32 v131, 1, v1
  v_lshlrev_b32 v131, 2, v131
  v_bfe_u32 v130, v1, 1, 2
  v_mul_u32_u24 v130, 8704, v130
  v_add_u32 v131, v130, v131
  s_mul_i32 s23, s13, 34816
  s_lshl_b32 s24, s12, 3
  s_add_u32 s23, s23, s24
  s_add_u32 s23, s23, 1642752
  v_add_u32 v131, s23, v131
  v_mov_b32 v128, v4
  v_mov_b32 v129, 0
  s_mov_b32 s26, 0
  s_cmp_eq_u32 s35, 0
  s_cbranch_scc1 B_lw_b1
  s_cmp_eq_u32 s36, 0
  s_cbranch_scc1 B_lw_b2
  s_cmp_eq_u32 s37, 0
  s_cbranch_scc1 B_lw_b3
  s_cmp_eq_u32 s38, 0
  s_cbranch_scc1 B_lw_b4
  s_cmp_eq_u32 s39, 0
  s_cbranch_scc1 B_lw_b5
  s_cmp_eq_u32 s40, 0
  s_cbranch_scc1 B_lw_b6
B_lw_b0:
  v_cmp_ge_u32 vcc, s26, v129
  s_cbranch_vccz B_lw_g0
  s_waitcnt vmcnt(16)
B_lw_c0:
  v_cmp_ge_u32 vcc, s26, v129
  s_cbranch_vccz B_lw_g0
  buffer_load_dword v129, v131, s[8:11], 0 offen sc1
  s_sub_u32 s25, s25, 1
  s_cbranch_scc1 abort
  s_sleep 8
  s_waitcnt vmcnt(0)
  s_branch B_lw_c0
B_lw_g0:
  buffer_load_dword v129, v131, s[8:11], 0 offen sc1
  buffer_load_dwordx4 a[0:3], v128, s[8:11], s72 offen offset:0
  buffer_load_dwordx4 a[4:7], v128, s[8:11], s72 offen offset:2048
  buffer_load_dwordx4 a[56:59], v128, s[8:11], s73 offen offset:0
  buffer_load_dwordx4 a[60:63], v128, s[8:11], s73 offen offset:2048
  buffer_load_dwordx4 a[112:115], v128, s[8:11], s74 offen offset:0
  buffer_load_dwordx4 a[116:119], v128, s[8:11], s74 offen offset:2048
  buffer_load_dwordx4 a[168:171], v128, s[8:11], s75 offen offset:0
  buffer_load_dwordx4 a[172:175], v128, s[8:11], s75 offen offset:2048
  buffer_load_dwordx4 a[224:227], v128, s[8:11], s76 offen offset:0
  buffer_load_dwordx4 a[228:231], v128, s[8:11], s76 offen offset:2048
  buffer_load_dwordx4 v[184:187], v128, s[8:11], s77 offen offset:0
  buffer_load_dwordx4 v[188:191], v128, s[8:11], s77 offen offset:2048
  buffer_load_dwordx4 v[240:243], v128, s[8:11], s78 offen offset:0
  buffer_load_dwordx4 v[244:247], v128, s[8:11], s78 offen offset:2048
  buffer_load_dwordx4 v[248:251], v128, s[8:11], s79 offen offset:0
  buffer_load_dwordx4 v[252:255], v128, s[8:11], s79 offen offset:2048
  v_add_u32 v128, 4096, v128
  s_add_u32 s26, s26, 1
  s_cmp_eq_u32 s26, 7
  s_waitcnt vmcnt(33)
  s_cbranch_scc1 B_lw_done
B_lw_b1:
  v_cmp_ge_u32 vcc, s26, v129
  s_cbranch_vccz B_lw_g1
  s_waitcnt vmcnt(16)
B_lw_c1:
  v_cmp_ge_u32 vcc, s26, v129
  s_cbranch_vccz B_lw_g1
  buffer_load_dword v129, v131, s[8:11], 0 offen sc1
  s_sub_u32 s25, s25, 1
  s_cbranch_scc1 abort
  s_sleep 8
  s_waitcnt vmcnt(0)
  s_branch B_lw_c1
B_lw_g1:
  buffer_load_dword v129, v131, s[8:11], 0 offen sc1
  buffer_load_dwordx4 a[8:11], v128, s[8:11], s72 offen offset:0
  buffer_load_dwordx4 a[12:15], v128, s[8:11], s72 offen offset:2048
  buffer_load_dwordx4 a[64:67], v128, s[8:11], s73 offen offset:0
  buffer_load_dwordx4 a[68:71], v128, s[8:11], s73 offen offset:2048
  buffer_load_dwordx4 a[120:123], v128, s[8:11], s74 offen offset:0
  buffer_load_dwordx4 a[124:127], v128, s[8:11], s74 offen offset:2048
  buffer_load_dwordx4 a[176:179], v128, s[8:11], s75 offen offset:0
  buffer_load_dwordx4 a[180:183], v128, s[8:11], s75 offen offset:2048
  buffer_load_dwordx4 a[232:235], v128, s[8:11], s76 offen offset:0
  buffer_load_dwordx4 a[236:239], v128, s[8:11], s76 offen offset:2048
  buffer_load_dwordx4 v[192:195], v128, s[8:11], s77 offen offset:0
  buffer_load_dwordx4 v[196:199], v128, s[8:11], s77 offen offset:2048
  s_add_u32 m0, s28, 0
  s_nop 0
  buffer_load_dwordx4 v128, s[8:11], s78 offen offset:0 lds
  s_add_u32 m0, s28, -1024
  s_nop 0
  buffer_load_dwordx4 v128, s[8:11], s78 offen offset:2048 lds
  s_add_u32 m0, s28, 2048
  s_nop 0
  buffer_load_dwordx4 v128, s[8:11], s79 offen offset:0 lds
  s_add_u32 m0, s28, 1024
  s_nop 0
  buffer_load_dwordx4 v128, s[8:11], s79 offen offset:2048 lds
  v_add_u32 v128, 4096, v128
  s_add_u32 s26, s26, 1
  s_cmp_eq_u32 s26, 7
  s_waitcnt vmcnt(33)
  s_cbranch_scc1 B_lw_done
B_lw_b2:
  v_cmp_ge_u32 vcc, s26, v129
  s_cbranch_vccz B_lw_g2
  s_waitcnt vmcnt(16)
B_lw_c2:
  v_cmp_ge_u32 vcc, s26, v129
  s_cbranch_vccz B_lw_g2
  buffer_load_dword v129, v131, s[8:11], 0 offen sc1
  s_sub_u32 s25, s25, 1
  s_cbranch_scc1 abort
  s_sleep 8
  s_waitcnt vmcnt(0)
  s_branch B_lw_c2
B_lw_g2:
  buffer_load_dword v129, v131, s[8:11], 0 offen sc1
  buffer_load_dwordx4 a[16:19], v128, s[8:11], s72 offen offset:0
  buffer_load_dwordx4 a[20:23], v128, s[8:11], s72 offen offset:2048
  buffer_load_dwordx4 a[72:75], v128, s[8:11], s73 offen offset:0
  buffer_load_dwordx4 a[76:79], v128, s[8:11], s73 offen offset:2048
  buffer_load_dwordx4 a[128:131], v128, s[8:11], s74 offen offset:0
  buffer_load_dwordx4 a[132:135], v128, s[8:11], s74 offen offset:2048
  buffer_load_dwordx4 a[184:187], v128, s[8:11], s75 offen offset:0
  buffer_load_dwordx4 a[188:191], v128, s[8:11], s75 offen offset:2048
  buffer_load_dwordx4 a[240:243], v128, s[8:11], s76 offen offset:0
  buffer_load_dwordx4 a[244:247], v128, s[8:11], s76 offen offset:2048
  buffer_load_dwordx4 v[200:203], v128, s[8:11], s77 offen offset:0
  buffer_load_dwordx4 v[204:207], v128, s[8:11], s77 offen offset:2048
  s_add_u32 m0, s28, 4096
  s_nop 0
  buffer_load_dwordx4 v128, s[8:11], s78 offen offset:0 lds
  s_add_u32 m0, s28, 3072
  s_nop 0
  buffer_load_dwordx4 v128, s[8:11], s78 offen offset:2048 lds
  s_add_u32 m0, s28, 6144
  s_nop 0
  buffer_load_dwordx4 v128, s[8:11], s79 offen offset:0 lds
  s_add_u32 m0, s28, 5120
  s_nop 0
  buffer_load_dwordx4 v128, s[8:11], s79 offen offset:2048 lds
  v_add_u32 v128, 4096, v128
  s_add_u32 s26, s26, 1
  s_cmp_eq_u32 s26, 7
  s_waitcnt vmcnt(33)
  s_cbranch_scc1 B_lw_done
B_lw_b3:
  v_cmp_ge_u32 vcc, s26, v129
  s_cbranch_vccz B_lw_g3
  s_waitcnt vmcnt(16)
B_lw_c3:
  v_cmp_ge_u32 vcc, s26, v129
  s_cbranch_vccz B_lw_g3
  buffer_load_dword v129, v131, s[8:11], 0 offen sc1
  s_sub_u32 s25, s25, 1
  s_cbranch_scc1 abort
  s_sleep 8
  s_waitcnt vmcnt(0)
  s_branch B_lw_c3
B_lw_g3:
  buffer_load_dword v129, v131, s[8:11], 0 offen sc1
  buffer_load_dwordx4 a[24:27], v128, s[8:11], s72 offen offset:0
  buffer_load_dwordx4 a[28:31], v128, s[8:11], s72 offen offset:2048
  buffer_load_dwordx4 a[80:83], v128, s[8:11], s73 offen offset:0
  buffer_load_dwordx4 a[84:87], v128, s[8:11], s73 offen offset:2048
  buffer_load_dwordx4 a[136:139], v128, s[8:11], s74 offen offset:0
  buffer_load_dwordx4 a[140:143], v128, s[8:11], s74 offen offset:2048
  buffer_load_dwordx4 a[192:195], v128, s[8:11], s75 offen offset:0
  buffer_load_dwordx4 a[196:199], v128, s[8:11], s75 offen offset:2048
  buffer_load_dwordx4 a[248:251], v128, s[8:11], s76 offen offset:0
  buffer_load_dwordx4 a[252:255], v128, s[8:11], s76 offen offset:2048
  buffer_load_dwordx4 v[208:211], v128, s[8:11], s77 offen offset:0
  buffer_load_dwordx4 v[212:215], v128, s[8:11], s77 offen offset:2048
  s_add_u32 m0, s28, 8192
  s_nop 0
  buffer_load_dwordx4 v128, s[8:11], s78 offen offset:0 lds
  s_add_u32 m0, s28, 7168
  s_nop 0
  buffer_load_dwordx4 v128, s[8:11], s78 offen offset:2048 lds
  s_add_u32 m0, s28, 10240
  s_nop 0
  buffer_load_dwordx4 v128, s[8:11], s79 offen offset:0 lds
  s_add_u32 m0, s28, 9216
  s_nop 0
  buffer_load_dwordx4 v128, s[8:11], s79 offen offset:2048 lds
  v_add_u32 v128, 4096, v128
  s_add_u32 s26, s26, 1
  s_cmp_eq_u32 s26, 7
  s_waitcnt vmcnt(33)
  s_cbranch_scc1 B_lw_done
B_lw_b4:
  v_cmp_ge_u32 vcc, s26, v129
  s_cbranch_vccz B_lw_g4
  s_waitcnt vmcnt(16)
B_lw_c4:
  v_cmp_ge_u32 vcc, s26, v129
  s_cbranch_vccz B_lw_g4
  buffer_load_dword v129, v131, s[8:11], 0 offen sc1
  s_sub_u32 s25, s25, 1
  s_cbranch_scc1 abort
  s_sleep 8
  s_waitcnt vmcnt(0)
  s_branch B_lw_c4
B_lw_g4:
  buffer_load_dword v129, v131, s[8:11], 0 offen sc1
  buffer_load_dwordx4 a[32:35], v128, s[8:11], s72 offen offset:0
  buffer_load_dwordx4 a[36:39], v128, s[8:11], s72 offen offset:2048
  buffer_load_dwordx4 a[88:91], v128, s[8:11], s73 offen offset:0
  buffer_load_dwordx4 a[92:95], v128, s[8:11], s73 offen offset:2048
  buffer_load_dwordx4 a[144:147], v128, s[8:11], s74 offen offset:0
  buffer_load_dwordx4 a[148:151], v128, s[8:11], s74 offen offset:2048
  buffer_load_dwordx4 a[200:203], v128, s[8:11], s75 offen offset:0
  buffer_load_dwordx4 a[204:207], v128, s[8:11], s75 offen offset:2048
  buffer_load_dwordx4 v[160:163], v128, s[8:11], s76 offen offset:0
  buffer_load_dwordx4 v[164:167], v128, s[8:11], s76 offen offset:2048
  buffer_load_dwordx4 v[216:219], v128, s[8:11], s77 offen offset:0
  buffer_load_dwordx4 v[220:223], v128, s[8:11], s77 offen offset:2048
  s_add_u32 m0, s28, 12288
  s_nop 0
  buffer_load_dwordx4 v128, s[8:11], s78 offen offset:0 lds
  s_add_u32 m0, s28, 11264
  s_nop 0
  buffer_load_dwordx4 v128, s[8:11], s78 offen offset:2048 lds
  s_add_u32 m0, s28, 14336
  s_nop 0
  buffer_load_dwordx4 v128, s[8:11], s79 offen offset:0 lds
  s_add_u32 m0, s28, 13312
  s_nop 0
  buffer_load_dwordx4 v128, s[8:11], s79 offen offset:2048 lds
  v_add_u32 v128, 4096, v128
  s_add_u32 s26, s26, 1
  s_cmp_eq_u32 s26, 7
  s_waitcnt vmcnt(33)
  s_cbranch_scc1 B_lw_done
B_lw_b5:
  v_cmp_ge_u32 vcc, s26, v129
  s_cbranch_vccz B_lw_g5
  s_waitcnt vmcnt(16)
B_lw_c5:
  v_cmp_ge_u32 vcc, s26, v129
  s_cbranch_vccz B_lw_g5
  buffer_load_dword v129, v131, s[8:11], 0 offen sc1
  s_sub_u32 s25, s25, 1
  s_cbranch_scc1 abort
  s_sleep 8
  s_waitcnt vmcnt(0)
  s_branch B_lw_c5
B_lw_g5:
  buffer_load_dword v129, v131, s[8:11], 0 offen sc1
  buffer_load_dwordx4 a[40:43], v128, s[8:11], s72 offen offset:0
  buffer_load_dwordx4 a[44:47], v128, s[8:11], s72 offen offset:2048
  buffer_load_dwordx4 a[96:99], v128, s[8:11], s73 offen offset:0
  buffer_load_dwordx4 a[100:103], v128, s[8:11], s73 offen offset:2048
  buffer_load_dwordx4 a[152:155], v128, s[8:11], s74 offen offset:0
  buffer_load_dwordx4 a[156:159], v128, s[8:11], s74 offen offset:2048
  buffer_load_dwordx4 a[208:211], v128, s[8:11], s75 offen offset:0
  buffer_load_dwordx4 a[212:215], v128, s[8:11], s75 offen offset:2048
  buffer_load_dwordx4 v[168:171], v128, s[8:11], s76 offen offset:0
  buffer_load_dwordx4 v[172:175], v128, s[8:11], s76 offen offset:2048
  buffer_load_dwordx4 v[224:227], v128, s[8:11], s77 offen offset:0
  buffer_load_dwordx4 v[228:231], v128, s[8:11], s77 offen offset:2048
  s_add_u32 m0, s28, 16384
  s_nop 0
  buffer_load_dwordx4 v128, s[8:11], s78 offen offset:0 lds
  s_add_u32 m0, s28, 15360
  s_nop 0
  buffer_load_dwordx4 v128, s[8:11], s78 offen offset:2048 lds
  s_add_u32 m0, s28, 18432
  s_nop 0
  buffer_load_dwordx4 v128, s[8:11], s79 offen offset:0 lds
  s_add_u32 m0, s28, 17408
  s_nop 0
  buffer_load_dwordx4 v128, s[8:11], s79 offen offset:2048 lds
  v_add_u32 v128, 4096, v128
  s_add_u32 s26, s26, 1
  s_cmp_eq_u32 s26, 7
  s_waitcnt vmcnt(33)
  s_cbranch_scc1 B_lw_done
B_lw_b6:
  v_cmp_ge_u32 vcc, s26, v129
  s_cbranch_vccz B_lw_g6
  s_waitcnt vmcnt(16)
B_lw_c6:
  v_cmp_ge_u32 vcc, s26, v129
  s_cbranch_vccz B_lw_g6
  buffer_load_dword v129, v131, s[8:11], 0 offen sc1
  s_sub_u32 s25, s25, 1
  s_cbranch_scc1 abort
  s_sleep 8
  s_waitcnt vmcnt(0)
  s_branch B_lw_c6
B_lw_g6:
  buffer_load_dword v129, v131, s[8:11], 0 offen sc1
  buffer_load_dwordx4 a[48:51], v128, s[8:11], s72 offen offset:0
  buffer_load_dwordx4 a[52:55], v128, s[8:11], s72 offen offset:2048
  buffer_load_dwordx4 a[104:107], v128, s[8:11], s73 offen offset:0
  buffer_load_dwordx4 a[108:111], v128, s[8:11], s73 offen offset:2048
  buffer_load_dwordx4 a[160:163], v128, s[8:11], s74 offen offset:0
  buffer_load_dwordx4 a[164:167], v128, s[8:11], s74 offen offset:2048
  buffer_load_dwordx4 a[216:219], v128, s[8:11], s75 offen offset:0
  buffer_load_dwordx4 a[220:223], v128, s[8:11], s75 offen offset:2048
  buffer_load_dwordx4 v[176:179], v128, s[8:11], s76 offen offset:0
  buffer_load_dwordx4 v[180:183], v128, s[8:11], s76 offen offset:2048
  buffer_load_dwordx4 v[232:235], v128, s[8:11], s77 offen offset:0
  buffer_load_dwordx4 v[236:239], v128, s[8:11], s77 offen offset:2048
  s_add_u32 m0, s28, 20480
  s_nop 0
  buffer_load_dwordx4 v128, s[8:11], s78 offen offset:0 lds
  s_add_u32 m0, s28, 19456
  s_nop 0
  buffer_load_dwordx4 v128, s[8:11], s78 offen offset:2048 lds
  s_add_u32 m0, s28, 22528
  s_nop 0
  buffer_load_dwordx4 v128, s[8:11], s79 offen offset:0 lds
  s_add_u32 m0, s28, 21504
  s_nop 0
  buffer_load_dwordx4 v128, s[8:11], s79 offen offset:2048 lds
  v_add_u32 v128, 4096, v128
  s_add_u32 s26, s26, 1
  s_cmp_eq_u32 s26, 7
  s_waitcnt vmcnt(33)
  s_cbranch_scc1 B_lw_done
  s_branch B_lw_b0
B_lw_done:
  s_bfe_u32 s20, s2, 0x40003
  s_mul_i32 s20, s20, 4352
  s_add_u32 s20, s20, 1812480
  v_and_b32 v112, 7, v1
  v_lshl_add_u32 v112, v112, 2, s20
  buffer_load_dword v113, v112, s[8:11], 0 offen sc1
  buffer_load_dword v114, v14, s[4:7], 0 offen sc1
  s_waitcnt vmcnt(18)
  v_add_u32 v130, s36, v8
  v_add_u32 v131, s37, v8
  v_add_u32 v132, s38, v8
  v_add_u32 v133, s39, v8
  v_add_u32 v134, s40, v8
  s_lshl_b32 s23, s13, 11
  v_add_u32 v9, s23, v8
  v_and_b32 v127, 7, v1
  v_lshlrev_b32 v10, 4, v127
  v_bfe_u32 v127, v1, 3, 1
  v_lshl_add_u32 v10, v127, 7, v10
  v_bfe_u32 v127, v1, 5, 1
  v_lshl_add_u32 v10, v127, 8, v10
  s_lshl_b32 s23, s13, 9
  s_add_u32 s23, s23, 8192
  v_add_u32 v10, s23, v10
  v_bfe_u32 v127, v1, 4, 1
  v_lshlrev_b32 v127, 5, v127
  v_xor_b32 v11, v127, v8
  s_lshl_b32 s23, s13, 10
  s_add_u32 s23, s23, 8192
  v_add_u32 v11, s23, v11
  v_and_b32 v12, 1, v1
  v_bfe_u32 v127, v1, 1, 1
  v_lshl_add_u32 v12, v127, 3, v12
  v_bfe_u32 v127, v1, 2, 1
  v_lshl_add_u32 v12, v127, 2, v12
  v_bfe_u32 v127, v1, 5, 1
  v_lshl_add_u32 v12, v127, 4, v12
  s_and_b32 s23, s13, 1
  v_xor_b32 v127, s23, v127
  v_lshl_add_u32 v12, v127, 1, v12
  v_lshlrev_b32 v12, 4, v12
  v_bfe_u32 v127, v1, 3, 2
  v_lshl_add_u32 v12, v127, 2, v12
  s_lshr_b32 s23, s13, 1
  s_lshl_b32 s23, s23, 9
  s_add_u32 s23, s23, 8192
  v_add_u32 v12, s23, v12
  v_lshlrev_b32 v124, 1, v1
  s_lshl_b32 s23, s12, 9
  s_lshl_b32 s24, s13, 7
  s_add_u32 s23, s23, s24
  s_add_u32 s23, s23, 7168
  v_add_u32 v124, s23, v124
  v_and_b32 v127, 1, v1
  v_cmp_eq_u32 vcc, 0, v127
  v_mov_b32 v128, 0x7f000000
  s_lshr_b32 s23, s34, 5
  s_lshr_b32 s24, s35, 5
  v_mov_b32 v127, s23
  v_mov_b32 v125, s24
  v_and_b32 v126, 8, v1
  v_cmp_eq_u32 vcc, 0, v126
  s_nop 1
  v_cndmask_b32 v125, v125, v127, vcc
  v_and_b32 v127, 7, v1
  v_lshl_add_u32 v125, v127, 2, v125
  s_lshr_b32 s23, s12, 2
  s_lshl_b32 s23, s23, 8
  s_add_u32 s23, s23, 43008
  v_add_u32 v125, s23, v125
  v_mov_b32 v127, 54528
  v_cmp_gt_u32 vcc, 32, v1
  s_nop 1
  v_cndmask_b32 v125, v127, v125, vcc
  v_lshrrev_b32 v143, 5, v1
  v_and_b32 v127, 3, v1
  v_lshlrev_b32 v140, 2, v127
  s_lshr_b32 s23, s12, 0
  s_lshl_b32 s23, s23, 7
  s_mul_i32 s24, s13, 16
  s_add_u32 s23, s23, s24
  s_add_u32 s23, s23, 40960
  v_add_u32 v140, s23, v140
  s_lshl_b32 s23, s12, 4
  s_lshl_b32 s24, s13, 2
  s_add_u32 s23, s23, s24
  s_add_u32 s23, s23, 43008
  v_lshlrev_b32 v141, 8, v1
  v_add_u32 v141, s23, v141
  v_cmp_gt_u32 vcc, 4, v1
  s_nop 1
  v_cndmask_b32 v141, v128, v141, vcc
  s_mul_i32 s19, s13, 56
  s_add_u32 s19, s19, s12
  s_lshl_b32 s19, s19, 11
  s_add_u32 s19, s19, 49135616
  v_lshrrev_b32 v126, 3, v1
  v_lshlrev_b32 v126, 4, v126
  v_and_b32 v127, 4, v1
  v_lshl_add_u32 v126, v127, 7, v126
  v_and_b32 v127, 2, v1
  v_lshl_add_u32 v126, v127, 2, v126
  s_lshl_b32 s23, s12, 11
  s_lshr_b32 s24, s13, 1
  s_lshl_b32 s24, s24, 10
  s_add_u32 s23, s23, s24
  s_and_b32 s24, s13, 1
  s_lshl_b32 s24, s24, 2
  s_add_u32 s23, s23, s24
  s_add_u32 s23, s23, 1610112
  v_and_b32 v127, 1, v1
  v_lshl_add_u32 v126, v127, 1, v126
  v_add_u32 v126, s23, v126
  s_branch B_fin
B_finx:
  s_waitcnt vmcnt(0)
  s_branch B_mode_cx_chk
B_mode_cx:
  buffer_load_dword v113, v112, s[8:11], 0 offen sc1
  s_waitcnt vmcnt(0)
B_mode_cx_chk:
  v_cmp_gt_u32 vcc, 32, v113
  s_cbranch_vccz B_mode_cx_ok
  s_sub_u32 s25, s25, 1
  s_cbranch_scc1 abort
  s_sleep 8
  s_branch B_mode_cx
B_mode_cx_ok:
  s_branch B_mode_chk
B_mode:
  buffer_load_dword v114, v14, s[4:7], 0 offen sc1
  s_waitcnt vmcnt(0)
B_mode_chk:
  v_and_b32 v115, 0xff, v114
  v_cmp_gt_u32 vcc, 32, v115
  s_nop 0
  s_and_b32 vcc_lo, vcc_lo, 0x10
  s_and_b32 vcc_hi, vcc_hi, 0x0
  s_or_b32 vcc_lo, vcc_lo, vcc_hi
  s_cbranch_scc0 B_mode_ok
  s_sub_u32 s25, s25, 1
  s_cbranch_scc1 abort
  s_sleep 8
  s_branch B_mode
B_mode_ok:
  v_readlane_b32 s21, v114, 4
  s_lshl_b32 s15, s15, 5
  s_sub_u32 s15, s15, s21
  s_cmp_lg_u32 s15, 0
  s_cselect_b32 s29, 0x7f000000, 0
  s_cselect_b32 s23, 0, 128
  v_mul_u32_u24 v127, s23, v143
  v_add_u32 v125, v127, v125
  s_waitcnt lgkmcnt(0)
.p2align 5
  s_nop 0
  s_nop 0
B_step:
  ds_read_b128 v[144:147], v13 offset:0
  ds_read_b128 v[148:151], v13 offset:1024
  ds_read_b128 v[152:155], v13 offset:2048
  ds_read_b128 v[156:159], v13 offset:3072
  buffer_load_dword v76, v125, s[8:11], 0 offen sc1
  v_mov_b32 v44, 0
  v_mov_b32 v45, 0
  v_mov_b32 v46, 0
  v_mov_b32 v47, 0
  v_mov_b32 v48, 0
  v_mov_b32 v49, 0
  v_mov_b32 v50, 0
  v_mov_b32 v51, 0
  buffer_load_dword v77, v125, s[8:11], 0 offen sc1
  v_mov_b32 v52, 0
  v_mov_b32 v53, 0
  v_mov_b32 v54, 0
  v_mov_b32 v55, 0
  v_mov_b32 v56, 0
  v_mov_b32 v57, 0
  v_mov_b32 v58, 0
  v_mov_b32 v59, 0
  v_mov_b32 v60, 0
  v_mov_b32 v61, 0
  v_mov_b32 v62, 0
  v_mov_b32 v63, 0
  v_mov_b32 v64, 0
  v_mov_b32 v65, 0
  v_mov_b32 v66, 0
  v_mov_b32 v67, 0
  v_mov_b32 v68, 0
  v_mov_b32 v69, 0
  v_mov_b32 v70, 0
  v_mov_b32 v71, 0
  v_mov_b32 v72, 0
  v_mov_b32 v73, 0
  v_mov_b32 v74, 0
  v_mov_b32 v75, 0
  buffer_load_dword v78, v125, s[8:11], 0 offen sc1
B_fm:
  s_waitcnt vmcnt(2)
  v_cmp_gt_u32 vcc, v143, v76
  s_cbranch_vccz B_fm_ok
  buffer_load_dword v76, v125, s[8:11], 0 offen sc1
  s_waitcnt vmcnt(2)
  v_cmp_gt_u32 vcc, v143, v77
  s_cbranch_vccz B_fm_ok
  buffer_load_dword v77, v125, s[8:11], 0 offen sc1
  s_waitcnt vmcnt(2)
  v_cmp_gt_u32 vcc, v143, v78
  s_cbranch_vccz B_fm_ok
  buffer_load_dword v78, v125, s[8:11], 0 offen sc1
  s_sub_u32 s25, s25, 1
  s_cbranch_scc0 B_fm
  s_branch abort
B_fm_ok:
B_poll:
  buffer_load_dwordx4 v[16:19], v6, s[8:11], s16 offen sc1
  buffer_load_dwordx4 v[20:23], v7, s[8:11], s16 offen sc1
  s_sub_u32 s25, s25, 1
  s_cbranch_scc1 abort
  s_waitcnt vmcnt(0)
  v_max_u32 v127, v16, v20
  v_cmp_eq_u32 vcc, -1, v127
  s_cbranch_vccnz B_poll
  v_smfmac_f32_16x16x64_bf16 v[44:47], v[16:19], a[0:7], v5
  ds_write_b128 v6, v[16:19] offset:0
  v_smfmac_f32_16x16x64_bf16 v[48:51], v[16:19], a[56:63], v5
  ds_write_b128 v7, v[20:23] offset:0
  v_smfmac_f32_16x16x64_bf16 v[52:55], v[16:19], a[112:119], v5
  s_add_u32 s22, s19, 0
  v_smfmac_f32_16x16x64_bf16 v[56:59], v[16:19], a[168:175], v5
  buffer_load_dwordx4 v[92:95], v4, s[8:11], s22 offen offset:0 sc1 nt
  v_smfmac_f32_16x16x64_bf16 v[60:63], v[16:19], a[224:231], v5
  s_add_u32 s22, s19, 0
  v_smfmac_f32_16x16x64_bf16 v[64:67], v[16:19], v[184:191], v5
  buffer_load_dwordx4 v[108:111], v4, s[8:11], s22 offen offset:256 sc1 nt
  v_smfmac_f32_16x16x64_bf16 v[68:71], v[16:19], v[240:247], v5
  s_waitcnt lgkmcnt(0)
  s_barrier
  v_smfmac_f32_16x16x64_bf16 v[72:75], v[16:19], v[248:255], v5
  ds_read_b128 v[24:27], v130 offset:0
  v_smfmac_f32_16x16x64_bf16 v[44:47], v[20:23], a[8:15], v5
  ds_read_b128 v[28:31], v131 offset:0
  v_smfmac_f32_16x16x64_bf16 v[48:51], v[20:23], a[64:71], v5
  ds_read_b128 v[32:35], v132 offset:0
  v_smfmac_f32_16x16x64_bf16 v[52:55], v[20:23], a[120:127], v5
  ds_read_b128 v[36:39], v133 offset:0
  v_smfmac_f32_16x16x64_bf16 v[56:59], v[20:23], a[176:183], v5
  ds_read_b128 v[40:43], v134 offset:0
  v_smfmac_f32_16x16x64_bf16 v[60:63], v[20:23], a[232:239], v5
  s_add_u32 s22, s19, 28672
  v_smfmac_f32_16x16x64_bf16 v[64:67], v[20:23], v[192:199], v5
  buffer_load_dwordx4 v[96:99], v4, s[8:11], s22 offen offset:0 sc1 nt
  v_smfmac_f32_16x16x64_bf16 v[68:71], v[20:23], v[144:151], v5
  s_add_u32 s22, s19, 28672
  v_smfmac_f32_16x16x64_bf16 v[72:75], v[20:23], v[152:159], v5
  buffer_load_dwordx4 v[112:115], v4, s[8:11], s22 offen offset:256 sc1 nt
  s_add_u32 s22, s19, 57344
  buffer_load_dwordx4 v[100:103], v4, s[8:11], s22 offen offset:0 sc1 nt
  s_waitcnt lgkmcnt(0)
  v_smfmac_f32_16x16x64_bf16 v[44:47], v[24:27], a[16:23], v5
  ds_read_b128 v[144:147], v13 offset:4096
  v_smfmac_f32_16x16x64_bf16 v[48:51], v[24:27], a[72:79], v5
  ds_read_b128 v[148:151], v13 offset:5120
  v_smfmac_f32_16x16x64_bf16 v[52:55], v[24:27], a[128:135], v5
  ds_read_b128 v[152:155], v13 offset:6144
  v_smfmac_f32_16x16x64_bf16 v[56:59], v[24:27], a[184:191], v5
  ds_read_b128 v[156:159], v13 offset:7168
  v_smfmac_f32_16x16x64_bf16 v[60:63], v[24:27], a[240:247], v5
  s_add_u32 s22, s19, 57344
  v_smfmac_f32_16x16x64_bf16 v[64:67], v[24:27], v[200:207], v5
  buffer_load_dwordx4 v[116:119], v4, s[8:11], s22 offen offset:256 sc1 nt
  s_add_u32 s22, s19, 86016
  buffer_load_dwordx4 v[104:107], v4, s[8:11], s22 offen offset:0 sc1 nt
  s_add_u32 s22, s19, 86016
  buffer_load_dwordx4 v[120:123], v4, s[8:11], s22 offen offset:256 sc1 nt
  s_waitcnt lgkmcnt(0)
  v_smfmac_f32_16x16x64_bf16 v[68:71], v[24:27], v[144:151], v5
  v_smfmac_f32_16x16x64_bf16 v[72:75], v[24:27], v[152:159], v5
  ds_read_b128 v[144:147], v13 offset:8192
  v_smfmac_f32_16x16x64_bf16 v[44:47], v[28:31], a[24:31], v5
  ds_read_b128 v[148:151], v13 offset:9216
  v_smfmac_f32_16x16x64_bf16 v[48:51], v[28:31], a[80:87], v5
  ds_read_b128 v[152:155], v13 offset:10240
  v_smfmac_f32_16x16x64_bf16 v[52:55], v[28:31], a[136:143], v5
  ds_read_b128 v[156:159], v13 offset:11264
  v_smfmac_f32_16x16x64_bf16 v[56:59], v[28:31], a[192:199], v5
  s_add_u32 s31, s14, 1
  s_add_u32 s30, s16, s29
  v_smfmac_f32_16x16x64_bf16 v[60:63], v[28:31], a[248:255], v5
  v_mov_b32 v142, s31
  v_smfmac_f32_16x16x64_bf16 v[64:67], v[28:31], v[208:215], v5
  s_waitcnt lgkmcnt(0)
  v_smfmac_f32_16x16x64_bf16 v[68:71], v[28:31], v[144:151], v5
  v_smfmac_f32_16x16x64_bf16 v[72:75], v[28:31], v[152:159], v5
  ds_read_b128 v[144:147], v13 offset:12288
  v_smfmac_f32_16x16x64_bf16 v[44:47], v[32:35], a[32:39], v5
  ds_read_b128 v[148:151], v13 offset:13312
  v_smfmac_f32_16x16x64_bf16 v[48:51], v[32:35], a[88:95], v5
  ds_read_b128 v[152:155], v13 offset:14336
  v_smfmac_f32_16x16x64_bf16 v[52:55], v[32:35], a[144:151], v5
  ds_read_b128 v[156:159], v13 offset:15360
  v_smfmac_f32_16x16x64_bf16 v[56:59], v[32:35], a[200:207], v5
  v_mov_b32 v28, 0
  v_smfmac_f32_16x16x64_bf16 v[60:63], v[32:35], v[160:167], v5
  v_mov_b32 v29, 0
  v_smfmac_f32_16x16x64_bf16 v[64:67], v[32:35], v[216:223], v5
  v_mov_b32 v30, 0
  v_mov_b32 v31, 0
  s_waitcnt lgkmcnt(0)
  v_smfmac_f32_16x16x64_bf16 v[68:71], v[32:35], v[144:151], v5
  v_smfmac_f32_16x16x64_bf16 v[72:75], v[32:35], v[152:159], v5
  ds_read_b128 v[144:147], v13 offset:16384
  v_smfmac_f32_16x16x64_bf16 v[44:47], v[36:39], a[40:47], v5
  ds_read_b128 v[148:151], v13 offset:17408
  v_smfmac_f32_16x16x64_bf16 v[44:47], v[40:43], a[48:55], v5
  ds_read_b128 v[152:155], v13 offset:18432
  v_smfmac_f32_16x16x64_bf16 v[48:51], v[36:39], a[96:103], v5
  ds_read_b128 v[156:159], v13 offset:19456
  v_smfmac_f32_16x16x64_bf16 v[48:51], v[40:43], a[104:111], v5
  v_cvt_pk_bf16_f32 v76, v44, v45
  v_smfmac_f32_16x16x64_bf16 v[52:55], v[36:39], a[152:159], v5
  v_cvt_pk_bf16_f32 v78, v46, v47
  v_smfmac_f32_16x16x64_bf16 v[52:55], v[40:43], a[160:167], v5
  s_waitcnt lgkmcnt(0)
  v_smfmac_f32_16x16x64_bf16 v[68:71], v[36:39], v[144:151], v5
  v_cvt_pk_bf16_f32 v84, v48, v49
  v_smfmac_f32_16x16x64_bf16 v[72:75], v[36:39], v[152:159], v5
  v_cvt_pk_bf16_f32 v86, v50, v51
  v_smfmac_f32_16x16x64_bf16 v[56:59], v[36:39], a[208:215], v5
  ds_read_b128 v[144:147], v13 offset:20480
  v_smfmac_f32_16x16x64_bf16 v[56:59], v[40:43], a[216:223], v5
  ds_read_b128 v[148:151], v13 offset:21504
  v_smfmac_f32_16x16x64_bf16 v[60:63], v[36:39], v[168:175], v5
  ds_read_b128 v[152:155], v13 offset:22528
  v_smfmac_f32_16x16x64_bf16 v[60:63], v[40:43], v[176:183], v5
  ds_read_b128 v[156:159], v13 offset:23552
  v_smfmac_f32_16x16x64_bf16 v[64:67], v[36:39], v[224:231], v5
  v_cvt_pk_bf16_f32 v77, v52, v53
  v_smfmac_f32_16x16x64_bf16 v[64:67], v[40:43], v[232:239], v5
  v_cvt_pk_bf16_f32 v79, v54, v55
  v_cvt_pk_bf16_f32 v85, v56, v57
  v_cvt_pk_bf16_f32 v87, v58, v59
  s_waitcnt lgkmcnt(0)
  v_smfmac_f32_16x16x64_bf16 v[68:71], v[40:43], v[144:151], v5
  v_cvt_pk_bf16_f32 v80, v60, v61
  v_smfmac_f32_16x16x64_bf16 v[72:75], v[40:43], v[152:159], v5
  v_cvt_pk_bf16_f32 v82, v62, v63
  v_mov_b32 v32, 0
  v_mov_b32 v33, 0
  v_mov_b32 v34, 0
  v_mov_b32 v35, 0
  v_cvt_pk_bf16_f32 v88, v64, v65
  v_cvt_pk_bf16_f32 v90, v66, v67
  s_cmp_eq_u32 s14, 63
  s_cbranch_scc1 B_fin
  v_cvt_pk_bf16_f32 v81, v68, v69
  v_cvt_pk_bf16_f32 v83, v70, v71
  v_cvt_pk_bf16_f32 v89, v72, v73
  v_cvt_pk_bf16_f32 v91, v74, v75
  s_sleep 3
  buffer_load_dword v44, v140, s[8:11], 0 offen sc1
  s_nop 11
  buffer_load_dword v45, v140, s[8:11], 0 offen sc1
  s_nop 11
  buffer_load_dword v46, v140, s[8:11], 0 offen sc1
  s_nop 11
  buffer_load_dword v47, v140, s[8:11], 0 offen sc1
.p2align 5
  s_nop 0
  s_nop 0
  s_nop 0
B_fl:
  s_waitcnt vmcnt(3)
  v_cmp_gt_u32 vcc, s31, v44
  s_cbranch_vccz B_fl_ok
  buffer_load_dword v44, v140, s[8:11], 0 offen sc1
  s_waitcnt vmcnt(3)
  v_cmp_gt_u32 vcc, s31, v45
  s_cbranch_vccz B_fl_ok
  buffer_load_dword v45, v140, s[8:11], 0 offen sc1
  s_waitcnt vmcnt(3)
  v_cmp_gt_u32 vcc, s31, v46
  s_cbranch_vccz B_fl_ok
  buffer_load_dword v46, v140, s[8:11], 0 offen sc1
  s_waitcnt vmcnt(3)
  v_cmp_gt_u32 vcc, s31, v47
  s_cbranch_vccz B_fl_ok
  buffer_load_dword v47, v140, s[8:11], 0 offen sc1
  s_sub_u32 s25, s25, 1
  s_cbranch_scc0 B_fl
  s_branch abort
.p2align 5
  s_nop 0
  s_nop 0
  s_nop 0
  s_nop 0
  s_nop 0
B_fl_ok:
  buffer_load_dwordx4 v[16:19], v9, s[8:11], s18 offen sc1
  buffer_load_dwordx4 v[20:23], v9, s[8:11], s18 offen offset:1024 sc1
  buffer_load_dwordx4 v[24:27], v10, s[8:11], s18 offen sc1
B_pollP:
  s_cmp_lg_u32 s15, 0
  s_waitcnt vmcnt(2)
  v_smfmac_f32_16x16x64_bf16 v[28:31], v[16:19], v[92:99], v5
  v_smfmac_f32_16x16x64_bf16 v[32:35], v[16:19], v[108:115], v5
  s_waitcnt vmcnt(1)
  v_smfmac_f32_16x16x64_bf16 v[28:31], v[20:23], v[100:107], v5
  v_smfmac_f32_16x16x64_bf16 v[32:35], v[20:23], v[116:123], v5
  s_waitcnt vmcnt(0)
  v_smfmac_f32_16x16x64_bf16 v[28:31], v[24:27], v[76:83], v5
  v_max3_u32 v127, v16, v20, v24
  v_smfmac_f32_16x16x64_bf16 v[32:35], v[24:27], v[84:91], v5
  v_cmp_eq_u32 vcc, -1, v127
  s_cbranch_vccnz B_retry
  s_nop 5
  v_permlane32_swap_b32 v28, v32
  v_permlane32_swap_b32 v29, v33
  v_permlane32_swap_b32 v30, v34
  v_permlane32_swap_b32 v31, v35
  v_pk_add_f32 v[28:29], v[28:29], v[32:33]
  v_pk_add_f32 v[30:31], v[30:31], v[34:35]
  ds_write_b128 v11, v[28:31]
  buffer_store_dword v142, v141, s[8:11], s29 offen
  s_waitcnt lgkmcnt(0)
  s_barrier
  ds_read2st64_b32 v[136:137], v12 offset0:0 offset1:4
  ds_read2st64_b32 v[138:139], v12 offset0:8 offset1:12
  s_waitcnt lgkmcnt(0)
  v_pk_add_f32 v[136:137], v[136:137], v[138:139]
  v_add_f32 v136, v136, v137
  v_cvt_pk_bf16_f32 v136, v136, v136
  buffer_store_short v136, v124, s[8:11], s30 offen
  s_cbranch_scc1 B_ms_slow
B_ms_done:
  s_add_u32 s14, s14, 1
  s_add_u32 s16, s16, 7168
  s_add_u32 s18, s18, 10240
  s_add_u32 s19, s19, 458752
  v_add_u32 v143, 1, v143
  s_cmp_lt_u32 s14, 63
  s_cbranch_scc1 B_step
  buffer_store_short v136, v126, s[8:11], 0 offen sc1
  s_branch B_step
B_fin:
  v_and_b32 v127, 15, v1
  v_lshlrev_b32 v127, 4, v127
  v_and_b32 v128, 16, v1
  v_lshl_add_u32 v127, v128, 5, v127
  v_and_b32 v128, 32, v1
  v_lshl_add_u32 v127, v128, 3, v127
  s_mul_i32 s23, s13, 28
  s_add_u32 s23, s23, s12
  s_lshl_b32 s23, s23, 10
  s_add_u32 s23, s23, 93061120
  s_cmp_eq_u32 s14, 0
  s_cselect_b32 s23, 0x7f000000, s23
  v_permlane32_swap_b32 v44, v48
  v_permlane32_swap_b32 v45, v49
  v_permlane32_swap_b32 v46, v50
  v_permlane32_swap_b32 v47, v51
  v_pk_add_f32 v[44:45], v[44:45], v[48:49]
  v_cvt_pk_bf16_f32 v76, v44, v45
  v_min_u32 v76, -2, v76
  v_pk_add_f32 v[46:47], v[46:47], v[50:51]
  v_cvt_pk_bf16_f32 v77, v46, v47
  v_min_u32 v77, -2, v77
  v_permlane32_swap_b32 v52, v56
  v_permlane32_swap_b32 v53, v57
  v_permlane32_swap_b32 v54, v58
  v_permlane32_swap_b32 v55, v59
  v_pk_add_f32 v[52:53], v[52:53], v[56:57]
  v_cvt_pk_bf16_f32 v78, v52, v53
  v_min_u32 v78, -2, v78
  v_pk_add_f32 v[54:55], v[54:55], v[58:59]
  v_cvt_pk_bf16_f32 v79, v54, v55
  v_min_u32 v79, -2, v79
  buffer_store_dwordx4 v[76:79], v127, s[8:11], s23 offen sc1
  s_add_u32 s23, s23, 14336
  v_permlane32_swap_b32 v60, v64
  v_permlane32_swap_b32 v61, v65
  v_permlane32_swap_b32 v62, v66
  v_permlane32_swap_b32 v63, v67
  v_pk_add_f32 v[60:61], v[60:61], v[64:65]
  v_cvt_pk_bf16_f32 v80, v60, v61
  v_min_u32 v80, -2, v80
  v_pk_add_f32 v[62:63], v[62:63], v[66:67]
  v_cvt_pk_bf16_f32 v81, v62, v63
  v_min_u32 v81, -2, v81
  v_permlane32_swap_b32 v68, v72
  v_permlane32_swap_b32 v69, v73
  v_permlane32_swap_b32 v70, v74
  v_permlane32_swap_b32 v71, v75
  v_pk_add_f32 v[68:69], v[68:69], v[72:73]
  v_cvt_pk_bf16_f32 v82, v68, v69
  v_min_u32 v82, -2, v82
  v_pk_add_f32 v[70:71], v[70:71], v[74:75]
  v_cvt_pk_bf16_f32 v83, v70, v71
  v_min_u32 v83, -2, v83
  buffer_store_dwordx4 v[80:83], v127, s[8:11], s23 offen sc1
  s_add_u32 s23, s23, 14336
  s_cmp_eq_u32 s14, 0
  s_cbranch_scc1 B_finx
  s_waitcnt vmcnt(0)
  s_endpgm
B_retry:
  s_sub_u32 s25, s25, 1
  s_cbranch_scc1 abort
  s_nop 7
  v_mov_b32 v28, 0
  v_mov_b32 v29, 0
  v_mov_b32 v30, 0
  v_mov_b32 v31, 0
  v_mov_b32 v32, 0
  v_mov_b32 v33, 0
  v_mov_b32 v34, 0
  v_mov_b32 v35, 0
  buffer_load_dwordx4 v[16:19], v9, s[8:11], s18 offen sc1
  buffer_load_dwordx4 v[20:23], v9, s[8:11], s18 offen offset:1024 sc1
  buffer_load_dwordx4 v[24:27], v10, s[8:11], s18 offen sc1
  s_branch B_pollP
B_ms_slow:
  buffer_store_short v136, v124, s[8:11], s16 offen sc1
  buffer_store_dword v142, v141, s[8:11], 0 offen sc1
  s_branch B_ms_done
roleP:
  v_and_b32 v1, 63, v0
  v_lshrrev_b32 v2, 6, v0
  s_nop 0
  v_readfirstlane_b32 s13, v2
  s_mov_b32 s25, 262144
  s_mov_b32 s27, 0
  s_cmp_lg_u32 s13, 0
  s_cbranch_scc1 P_mon_ok
  v_and_b32 v8, 7, v1
  v_mul_u32_u24 v9, 4352, v8
  v_add_u32 v9, 1777664, v9
  v_lshrrev_b32 v10, 3, v1
  v_mul_u32_u24 v10, 4352, v10
  v_lshl_add_u32 v10, v8, 2, v10
  s_mul_i32 s23, s12, 34816
  s_add_u32 s23, s23, 1812480
  s_mov_b32 s24, -1
P_mon:
  buffer_load_dword v11, v9, s[8:11], 0 offen sc1
  s_sub_u32 s25, s25, 1
  s_cbranch_scc1 abort
  s_waitcnt vmcnt(0)
  v_cmp_gt_u32 vcc, 32, v11
  s_nop 0
  s_cmp_eq_u32 vcc_lo, s24
  s_cbranch_scc1 P_mon
  s_mov_b32 s24, vcc_lo
  buffer_store_dword v11, v10, s[8:11], s23 offen sc1
  s_cbranch_vccnz P_mon
P_mon_ok:
  s_barrier
  s_cmp_eq_u32 s13, 3
  s_cbranch_scc1 P_pub
  v_min_u32 v2, 47, v1
  v_lshlrev_b32 v2, 7, v2
  s_mov_b32 s23, 40960
  buffer_load_dword v10, v2, s[8:11], s23 offen sc1
  s_mul_i32 s21, s12, 3
  s_add_u32 s21, s21, s13
  s_mul_i32 s23, s21, 60
  v_add_u32 v2, s23, v1
  v_lshlrev_b32 v3, 7, v2
  v_mov_b32 v4, 0
  v_mov_b32 v5, 0
  v_cmp_le_u32 vcc, 0, v2
  v_add_u32 v6, 0x1cc000, v3
  s_nop 0
  v_cndmask_b32 v4, v4, v6, vcc
  v_mov_b32 v6, 28672
  v_cndmask_b32 v5, v5, v6, vcc
  v_cmp_le_u32 vcc, 224, v2
  v_add_u32 v6, 0x9000, v3
  s_nop 0
  v_cndmask_b32 v4, v4, v6, vcc
  v_mov_b32 v6, 7168
  v_cndmask_b32 v5, v5, v6, vcc
  v_cmp_le_u32 vcc, 280, v2
  v_add_u32 v6, 0x77400, v3
  s_nop 0
  v_cndmask_b32 v4, v4, v6, vcc
  v_mov_b32 v6, 10240
  v_cndmask_b32 v5, v5, v6, vcc
  v_cmp_le_u32 vcc, 60, v1
  v_mov_b32 v6, 0x7f000000
  s_nop 0
  v_cndmask_b32 v4, v4, v6, vcc
  v_mov_b32 v8, 43776
  v_mov_b32 v7, 54528
  v_cmp_eq_u32 vcc, 0, v1
  s_nop 1
  v_cndmask_b32 v8, v7, v8, vcc
  v_cndmask_b32 v7, v6, v7, vcc
  s_mov_b32 s14, 0
  s_cmp_eq_u32 s21, 1
  s_cselect_b32 s27, 0, 64
P_wait:
  s_cmp_ge_u32 s27, 64
  s_cbranch_scc1 P_w2
  s_mov_b32 s22, s27
  v_lshlrev_b32 v12, 7, v1
  s_mov_b32 s24, 0
  buffer_load_dword v13, v12, s[8:11], s24 offen sc1
  s_waitcnt vmcnt(0)
  v_cmp_gt_u32 vcc, 28, v13
  s_nop 0
  s_ff1_i32_b64 s27, vcc
  s_min_u32 s27, s27, 64
  s_cmp_eq_u32 s22, s27
  s_cbranch_scc1 P_w2
  v_mov_b32 v12, s27
  buffer_store_dword v12, v7, s[8:11], 0 offen offset:128
  buffer_store_dword v12, v7, s[8:11], 0 offen sc1
P_w2:
  buffer_load_ushort v9, v8, s[8:11], 0 offen sc1
  s_sub_u32 s25, s25, 1
  s_cbranch_scc1 abort
  s_waitcnt vmcnt(0)
  v_readlane_b32 s23, v9, 0
  v_readlane_b32 s22, v9, 1
  s_add_u32 s24, s23, 6
  s_cmp_eq_u32 s23, 0
  s_cselect_b32 s24, 3, s24
  s_min_u32 s24, s24, 63
  s_or_b32 s22, s22, s14
  s_cmp_eq_u32 s22, 0
  s_cbranch_scc1 P_sl
  s_cmp_le_u32 s14, s24
  s_cbranch_scc1 P_go
P_sl:
  s_sleep 4
  s_branch P_wait
P_go:
  v_mov_b32 v8, 43776
  buffer_load_dword v10, v4, s[8:11], 0 offen
  v_add_u32 v4, v5, v4
  s_add_u32 s14, s14, 1
  s_cmp_le_u32 s14, s24
  s_cbranch_scc1 P_go
  s_cmp_lt_u32 s14, 64
  s_cbranch_scc1 P_wait
  s_cmp_lt_u32 s27, 64
  s_cbranch_scc1 P_wait
  s_endpgm
P_pub:
  s_mul_i32 s16, s12, 7168
  s_add_u32 s16, s16, 65536
  v_lshlrev_b32 v8, 4, v1
  v_lshrrev_b32 v9, 3, v1
  v_lshlrev_b32 v9, 9, v9
  v_and_b32 v11, 7, v1
  v_lshl_add_u32 v9, v11, 4, v9
  s_mov_b32 s14, s12
P_pw:
  s_add_u32 s23, s16, 4096
  buffer_load_dwordx4 v[40:43], v8, s[8:11], s23 offen offset:2048 sc1
  s_sub_u32 s25, s25, 1
  s_cbranch_scc1 abort
  s_waitcnt vmcnt(0)
  v_max3_u32 v12, v40, v41, v42
  v_max_u32 v12, v12, v43
  v_cmp_eq_u32 vcc, -1, v12
  s_cbranch_vccz P_pa
  s_sleep 4
  s_branch P_pw
P_pa:
  buffer_load_dwordx4 v[16:19], v8, s[8:11], s16 offen offset:0 sc1
  buffer_load_dwordx4 v[20:23], v8, s[8:11], s16 offen offset:1024 sc1
  buffer_load_dwordx4 v[24:27], v8, s[8:11], s16 offen offset:2048 sc1
  buffer_load_dwordx4 v[28:31], v8, s[8:11], s16 offen offset:3072 sc1
  buffer_load_dwordx4 v[32:35], v8, s[8:11], s23 offen offset:0 sc1
  buffer_load_dwordx4 v[36:39], v8, s[8:11], s23 offen offset:1024 sc1
  s_lshr_b32 s29, s14, 2
  s_mul_i32 s29, s29, 28672
  s_and_b32 s24, s14, 3
  s_lshl_b32 s24, s24, 7
  s_add_u32 s29, s29, s24
  s_add_u32 s29, s29, 1179648
  s_waitcnt vmcnt(0)
  v_max3_u32 v12, v16, v17, v18
  v_max3_u32 v12, v12, v19, v20
  v_max3_u32 v12, v12, v21, v22
  v_max3_u32 v12, v12, v23, v24
  v_max3_u32 v12, v12, v25, v26
  v_max3_u32 v12, v12, v27, v28
  v_max3_u32 v12, v12, v29, v30
  v_max3_u32 v12, v12, v31, v32
  v_max3_u32 v12, v12, v33, v34
  v_max3_u32 v12, v12, v35, v36
  v_max3_u32 v12, v12, v37, v38
  v_max_u32 v12, v12, v39
  v_cmp_eq_u32 vcc, -1, v12
  s_cbranch_vccnz P_pw
  v_mov_b32 v48, v16
  v_mov_b32 v49, v18
  v_mov_b32 v50, v17
  v_mov_b32 v51, v19
  v_mov_b32_dpp v48, v18 row_ror:8 row_mask:0xf bank_mask:0xc
  v_mov_b32_dpp v49, v16 row_ror:8 row_mask:0xf bank_mask:0x3
  v_mov_b32_dpp v50, v19 row_ror:8 row_mask:0xf bank_mask:0xc
  v_mov_b32_dpp v51, v17 row_ror:8 row_mask:0xf bank_mask:0x3
  buffer_store_dwordx4 v[48:51], v9, s[8:11], s29 offen sc1
  s_add_u32 s29, s29, 4096
  v_mov_b32 v52, v20
  v_mov_b32 v53, v22
  v_mov_b32 v54, v21
  v_mov_b32 v55, v23
  v_mov_b32_dpp v52, v22 row_ror:8 row_mask:0xf bank_mask:0xc
  v_mov_b32_dpp v53, v20 row_ror:8 row_mask:0xf bank_mask:0x3
  v_mov_b32_dpp v54, v23 row_ror:8 row_mask:0xf bank_mask:0xc
  v_mov_b32_dpp v55, v21 row_ror:8 row_mask:0xf bank_mask:0x3
  buffer_store_dwordx4 v[52:55], v9, s[8:11], s29 offen sc1
  s_add_u32 s29, s29, 4096
  v_mov_b32 v56, v24
  v_mov_b32 v57, v26
  v_mov_b32 v58, v25
  v_mov_b32 v59, v27
  v_mov_b32_dpp v56, v26 row_ror:8 row_mask:0xf bank_mask:0xc
  v_mov_b32_dpp v57, v24 row_ror:8 row_mask:0xf bank_mask:0x3
  v_mov_b32_dpp v58, v27 row_ror:8 row_mask:0xf bank_mask:0xc
  v_mov_b32_dpp v59, v25 row_ror:8 row_mask:0xf bank_mask:0x3
  buffer_store_dwordx4 v[56:59], v9, s[8:11], s29 offen sc1
  s_add_u32 s29, s29, 4096
  v_mov_b32 v60, v28
  v_mov_b32 v61, v30
  v_mov_b32 v62, v29
  v_mov_b32 v63, v31
  v_mov_b32_dpp v60, v30 row_ror:8 row_mask:0xf bank_mask:0xc
  v_mov_b32_dpp v61, v28 row_ror:8 row_mask:0xf bank_mask:0x3
  v_mov_b32_dpp v62, v31 row_ror:8 row_mask:0xf bank_mask:0xc
  v_mov_b32_dpp v63, v29 row_ror:8 row_mask:0xf bank_mask:0x3
  buffer_store_dwordx4 v[60:63], v9, s[8:11], s29 offen sc1
  s_add_u32 s29, s29, 4096
  v_mov_b32 v64, v32
  v_mov_b32 v65, v34
  v_mov_b32 v66, v33
  v_mov_b32 v67, v35
  v_mov_b32_dpp v64, v34 row_ror:8 row_mask:0xf bank_mask:0xc
  v_mov_b32_dpp v65, v32 row_ror:8 row_mask:0xf bank_mask:0x3
  v_mov_b32_dpp v66, v35 row_ror:8 row_mask:0xf bank_mask:0xc
  v_mov_b32_dpp v67, v33 row_ror:8 row_mask:0xf bank_mask:0x3
  buffer_store_dwordx4 v[64:67], v9, s[8:11], s29 offen sc1
  s_add_u32 s29, s29, 4096
  v_mov_b32 v68, v36
  v_mov_b32 v69, v38
  v_mov_b32 v70, v37
  v_mov_b32 v71, v39
  v_mov_b32_dpp v68, v38 row_ror:8 row_mask:0xf bank_mask:0xc
  v_mov_b32_dpp v69, v36 row_ror:8 row_mask:0xf bank_mask:0x3
  v_mov_b32_dpp v70, v39 row_ror:8 row_mask:0xf bank_mask:0xc
  v_mov_b32_dpp v71, v37 row_ror:8 row_mask:0xf bank_mask:0x3
  buffer_store_dwordx4 v[68:71], v9, s[8:11], s29 offen sc1
  s_add_u32 s29, s29, 4096
  v_mov_b32 v72, v40
  v_mov_b32 v73, v42
  v_mov_b32 v74, v41
  v_mov_b32 v75, v43
  v_mov_b32_dpp v72, v42 row_ror:8 row_mask:0xf bank_mask:0xc
  v_mov_b32_dpp v73, v40 row_ror:8 row_mask:0xf bank_mask:0x3
  v_mov_b32_dpp v74, v43 row_ror:8 row_mask:0xf bank_mask:0xc
  v_mov_b32_dpp v75, v41 row_ror:8 row_mask:0xf bank_mask:0x3
  buffer_store_dwordx4 v[72:75], v9, s[8:11], s29 offen sc1
  s_add_u32 s29, s29, 4096
  s_add_u32 s16, s16, 14336
  s_add_u32 s14, s14, 2
  s_cmp_lt_u32 s14, 63
  s_cbranch_scc1 P_pw
  s_endpgm
.section .rodata,"a"
.p2align 6
.amdhsa_kernel main_kernel
  .amdhsa_next_free_vgpr 512
  .amdhsa_next_free_sgpr 102
  .amdhsa_accum_offset 256
  .amdhsa_group_segment_fixed_size 0
  .amdhsa_kernarg_size 104
  .amdhsa_user_sgpr_count 2
  .amdhsa_user_sgpr_kernarg_segment_ptr 1
  .amdhsa_system_sgpr_workgroup_id_x 1
.end_amdhsa_kernel
```
